```python
import torch

def _softmax(x, axis=-1):
    return torch.softmax(x, dim=axis)

def _gelu(x):
    return torch.nn.functional.gelu(x, approximate='tanh')

def _silu(x):
    return torch.nn.functional.silu(x)

def _sigmoid(x):
    return torch.sigmoid(x)

def _layernorm(x, axis=-1, eps=1e-05):
    m = x.mean(dim=axis, keepdim=True)
    v = x.var(dim=axis, keepdim=True, unbiased=False)
    return (x - m) / torch.sqrt(v + eps)

def _scatter_add(tgt, idx, src, axis=0):
    return tgt.clone().index_add_(axis, idx, src)

def _segment_sum(src, seg, n):
    out = torch.zeros((n,) + src.shape[1:], dtype=src.dtype)
    return out.index_add_(0, seg, src)

def _pad(x, pw):
    flat = tuple((v for pair in reversed(pw) for v in pair))
    return torch.nn.functional.pad(x, flat)
kernel_name = 'standalone__video_video_swin__vision'

def setup_inputs():

    _w = lambda a: (lambda t: t.to(torch.bfloat16) if t.is_floating_point() else t)(torch.as_tensor(a))
    T = 4
    H = W = 224 // 7 * 7
    C, win = (96, 7)
    return {'x': _w((lambda *s: torch.randn(*s, dtype=torch.bfloat16) * 0.1)(1, T, H, W, C)), 'wqkv_t': _w((lambda *s: torch.randn(*s, dtype=torch.bfloat16) * 0.1)(C, 3 * C)), 'wo_t': _w((lambda *s: torch.randn(*s, dtype=torch.bfloat16) * 0.1)(C, C)), 'wqkv_s': _w((lambda *s: torch.randn(*s, dtype=torch.bfloat16) * 0.1)(C, 3 * C)), 'wo_s': _w((lambda *s: torch.randn(*s, dtype=torch.bfloat16) * 0.05)(C, C))}

def reference(x, wqkv_t, wo_t, wqkv_s, wo_s):
    B, T, H, W, C = x.shape
    win = 7
    scale = C ** (-0.5)
    h = _layernorm(x, axis=-1)
    ht = (lambda x, *d: x.permute(*d))(h, 0, 2, 3, 1, 4).reshape(B * H * W, T, C)
    qkv = ht @ wqkv_t
    q, k, v = (qkv[..., :C].clone(), qkv[..., C:2 * C].clone(), qkv[..., 2 * C:].clone())
    p = _softmax(torch.einsum('btc,bsc->bts', q, k) * scale, axis=-1)
    ot = torch.einsum('bts,bsc->btc', p, v) @ wo_t
    ot = (lambda x, *d: x.permute(*d))(ot.reshape(B, H, W, T, C), 0, 3, 1, 2, 4)
    x = x + ot
    h = _layernorm(x, axis=-1)
    nh, nw = (H // win, W // win)
    hs = h.reshape(B * T, nh, win, nw, win, C)
    hw = (lambda x, *d: x.permute(*d))(hs, 0, 1, 3, 2, 4, 5).reshape(B * T * nh * nw, win * win, C)
    qkv = hw @ wqkv_s
    q, k, v = (qkv[..., :C].clone(), qkv[..., C:2 * C].clone(), qkv[..., 2 * C:].clone())
    p = _softmax(torch.einsum('bqc,bkc->bqk', q, k) * scale, axis=-1)
    os = torch.einsum('bqk,bkc->bqc', p, v) @ wo_s
    os = (lambda x, *d: x.permute(*d))(os.reshape(B * T, nh, nw, win, win, C), 0, 1, 3, 2, 4, 5)
    os = os.reshape(B, T, H, W, C)
    return x + os
```

```asm
; @launch grid=(256,1,1) block=(512,1,1) lds=163840
.amdgcn_target "amdgcn-amd-amdhsa--gfx950"
.text
.globl standalone__video_video_swin__vision_kernel
.p2align 8
.type standalone__video_video_swin__vision_kernel,@function
standalone__video_video_swin__vision_kernel:
  s_cmp_ge_u32 s2, 0x100
  s_cbranch_scc1 MAIN_END
  s_load_dwordx16 s[80:95], s[0:1], 0
  s_getpc_b64 s[4:5]
CODE_BEG:
  v_lshlrev_b32 v16, 6, v0
  v_min_u32 v16, MAIN_END-CODE_BEG, v16
  v_mov_b32 v19, s5
  v_add_co_u32 v18, vcc, s4, v16
  v_addc_co_u32 v19, vcc, 0, v19, vcc
  global_load_dword v60, v[18:19], off
  v_lshrrev_b32 v1, 6, v0
  v_and_b32 v0, 63, v0
  s_nop 0
  v_readfirstlane_b32 s20, v1
  v_add_u32 v14, 0, v0
  v_mul_u32_u24 v15, 0x1556, v14
  v_lshrrev_b32 v8, 16, v15
  v_mul_u32_u24 v15, 12, v8
  v_sub_u32 v14, v14, v15
  v_bfe_u32 v15, v8, 2, 2
  v_xor_b32 v14, v14, v15
  v_lshlrev_b32 v11, 4, v14
  v_add_u32 v14, 64, v0
  v_mul_u32_u24 v15, 0x1556, v14
  v_lshrrev_b32 v9, 16, v15
  v_mul_u32_u24 v15, 12, v9
  v_sub_u32 v14, v14, v15
  v_bfe_u32 v15, v9, 2, 2
  v_xor_b32 v14, v14, v15
  v_lshlrev_b32 v12, 4, v14
  v_add_u32 v14, 0x80, v0
  v_mul_u32_u24 v15, 0x1556, v14
  v_lshrrev_b32 v10, 16, v15
  v_mul_u32_u24 v15, 12, v10
  v_sub_u32 v14, v14, v15
  v_bfe_u32 v15, v10, 2, 2
  v_xor_b32 v14, v14, v15
  v_lshlrev_b32 v13, 4, v14
  s_lshr_b32 s21, s2, 3
  s_and_b32 s22, s2, 7
  s_mul_i32 s21, s21, 0x49800
  s_mul_i32 s22, s22, 0x1500
  s_add_u32 s22, s22, s21
  s_mov_b32 s25, 0
  s_mov_b32 s26, 0x9000
  s_mov_b32 s75, 0
  s_mov_b64 vcc, 0
  s_cmp_ge_u32 s20, 4
  s_cbranch_scc1 S_PRO
  s_mul_i32 s51, s20, 0x4800
  s_add_u32 s51, s51, 0x9000
  s_cmp_ge_u32 s20, 2
  s_cselect_b32 s48, 0x9000, 0
  s_add_u32 s51, s51, s48
  s_movk_i32 s48, 0x240
  s_mov_b32 s18, 0xd800
  s_cmp_eq_u32 s20, 3
  s_cselect_b32 s48, 0xc0, s48
  s_mul_i32 s49, s20, 0xc0
  s_cselect_b32 s49, 0, s49
  s_cselect_b32 s18, 0x4800, s18
  s_lshl_b32 s50, s48, 4
  v_mad_u32_u24 v14, v8, s48, v11
  v_mad_u32_u24 v15, v9, s48, v12
  v_mad_u32_u24 v16, v10, s48, v13
  s_bitcmp0_b32 s20, 0
  s_cselect_b32 s4, 28, 9
  s_movk_i32 s6, 0x4800
  s_cselect_b32 s6, 0xd800, s6
  s_lshr_b32 s5, s2, 3
  s_mul_i32 s5, s5, s4
  v_add_u32 v40, s5, v0
  v_lshlrev_b32 v40, 6, v40
  v_cmp_gt_u32_e64 s[4:5], s4, v0
  v_mov_b32 v41, 0x80000000
  s_mov_b32 s7, 0x20000
  v_cndmask_b32_e64 v40, v41, v40, s[4:5]
  s_mov_b32 s19, 0x20000
  s_cmp_ge_u32 s20, 2
  s_waitcnt lgkmcnt(0)
  s_cselect_b64 s[4:5], s[86:87], s[82:83]
  s_cselect_b64 s[8:9], s[88:89], s[84:85]
  s_bitcmp1_b32 s20, 0
  s_cselect_b64 s[4:5], s[8:9], s[4:5]
  buffer_load_dword v200, v40, s[4:7], 0 offen
  s_cmp_eq_u32 s20, 3
  s_cselect_b32 s16, s84, s82
  s_cselect_b32 s17, s85, s83
  s_add_u32 m0, s51, 0
  s_nop 0
  buffer_load_dwordx4 v14, s[16:19], s49 offen lds
  s_add_u32 m0, s51, 0x400
  s_nop 0
  buffer_load_dwordx4 v15, s[16:19], s49 offen lds
  s_add_u32 m0, s51, 0x800
  s_nop 0
  buffer_load_dwordx4 v16, s[16:19], s49 offen lds
  s_add_u32 s49, s49, s50
  s_add_u32 m0, s51, 0xc00
  s_nop 0
  buffer_load_dwordx4 v14, s[16:19], s49 offen lds
  s_add_u32 m0, s51, 0x1000
  s_nop 0
  buffer_load_dwordx4 v15, s[16:19], s49 offen lds
  s_add_u32 m0, s51, 0x1400
  s_nop 0
  buffer_load_dwordx4 v16, s[16:19], s49 offen lds
  s_add_u32 s49, s49, s50
  s_add_u32 m0, s51, 0x1800
  s_nop 0
  buffer_load_dwordx4 v14, s[16:19], s49 offen lds
  s_add_u32 m0, s51, 0x1c00
  s_nop 0
  buffer_load_dwordx4 v15, s[16:19], s49 offen lds
  s_add_u32 m0, s51, 0x2000
  s_nop 0
  buffer_load_dwordx4 v16, s[16:19], s49 offen lds
  s_add_u32 s49, s49, s50
  s_add_u32 m0, s51, 0x2400
  s_nop 0
  buffer_load_dwordx4 v14, s[16:19], s49 offen lds
  s_add_u32 m0, s51, 0x2800
  s_nop 0
  buffer_load_dwordx4 v15, s[16:19], s49 offen lds
  s_add_u32 m0, s51, 0x2c00
  s_nop 0
  buffer_load_dwordx4 v16, s[16:19], s49 offen lds
  s_add_u32 s49, s49, s50
  s_add_u32 m0, s51, 0x3000
  s_nop 0
  buffer_load_dwordx4 v14, s[16:19], s49 offen lds
  s_add_u32 m0, s51, 0x3400
  s_nop 0
  buffer_load_dwordx4 v15, s[16:19], s49 offen lds
  s_add_u32 m0, s51, 0x3800
  s_nop 0
  buffer_load_dwordx4 v16, s[16:19], s49 offen lds
  s_add_u32 s49, s49, s50
  s_add_u32 m0, s51, 0x3c00
  s_nop 0
  buffer_load_dwordx4 v14, s[16:19], s49 offen lds
  s_add_u32 m0, s51, 0x4000
  s_nop 0
  buffer_load_dwordx4 v15, s[16:19], s49 offen lds
  s_add_u32 m0, s51, 0x4400
  s_nop 0
  buffer_load_dwordx4 v16, s[16:19], s49 offen lds
  s_mov_b32 s27, 0x41622adf
  s_mov_b32 s28, 0xbc2aaaab
  s_mov_b32 s30, 0xf0000f
  s_mov_b32 s31, 0xf0000f00
  s_mov_b32 s32, 0x22222222
  s_mov_b32 s33, 0x22222222
  s_mov_b32 s34, 0x44444444
  s_mov_b32 s35, 0x44444444
  s_mov_b32 s36, 0x88888888
  s_mov_b32 s37, 0x88888888
  v_mov_b32 v112, 0
  v_mov_b32 v113, 0
  v_mov_b32 v114, 0
  v_mov_b32 v115, 0
  s_lshl_b32 s49, s20, 10
  s_add_u32 s49, s49, 0x24c00
  v_lshlrev_b32 v30, 4, v0
  v_add_u32 v31, s49, v30
  ds_write_b128 v31, v[112:115]
  s_cmp_eq_u32 s20, 3
  s_cselect_b32 s60, 0, s20
  s_cselect_b32 s65, 2, 1
  s_branch JOIN
S_PRO:
  s_sub_u32 s21, s20, 4
  s_lshl_b32 s48, s21, 4
  s_movk_i32 s49, 0xc0
  s_mov_b32 s50, 0xa2c0
  v_xor_b32 v14, s48, v11
  v_mad_u32_u24 v14, v8, s49, v14
  v_lshlrev_b32 v27, 16, v8
  v_xor_b32 v15, s48, v12
  v_mad_u32_u24 v15, v9, s49, v15
  v_lshlrev_b32 v28, 16, v9
  v_xor_b32 v16, s48, v13
  v_mad_u32_u24 v16, v10, s49, v16
  v_lshlrev_b32 v29, 16, v10
  v_mul_hi_u32_u24 v42, 0x2493, v27
  v_mad_u32_u24 v30, v42, s50, v14
  v_mul_hi_u32_u24 v42, 0x2493, v28
  v_mad_u32_u24 v31, v42, s50, v15
  v_mul_hi_u32_u24 v42, 0x2493, v29
  v_mad_u32_u24 v32, v42, s50, v16
  v_add_u32 v40, 0x100000, v27
  v_add_u32 v41, 0xc00, v14
  v_mul_hi_u32_u24 v42, 0x2493, v40
  v_mad_u32_u24 v33, v42, s50, v41
  v_add_u32 v40, 0x100000, v28
  v_add_u32 v41, 0xc00, v15
  v_mul_hi_u32_u24 v42, 0x2493, v40
  v_mad_u32_u24 v34, v42, s50, v41
  v_add_u32 v40, 0x100000, v29
  v_add_u32 v41, 0xc00, v16
  v_mul_hi_u32_u24 v42, 0x2493, v40
  v_mad_u32_u24 v35, v42, s50, v41
  v_add_u32 v40, 0x200000, v27
  v_add_u32 v41, 0x1800, v14
  v_mul_hi_u32_u24 v42, 0x2493, v40
  v_mad_u32_u24 v36, v42, s50, v41
  v_add_u32 v40, 0x200000, v28
  v_add_u32 v41, 0x1800, v15
  v_mul_hi_u32_u24 v42, 0x2493, v40
  v_mad_u32_u24 v37, v42, s50, v41
  v_add_u32 v40, 0x200000, v29
  v_add_u32 v41, 0x1800, v16
  v_mul_hi_u32_u24 v42, 0x2493, v40
  v_mad_u32_u24 v38, v42, s50, v41
  s_mul_i32 s49, s21, 0x930000
  s_add_u32 s23, s22, s49
  s_mov_b32 s24, s23
  s_mul_i32 s50, s21, 0x2400
  s_add_u32 s44, s50, 0x12000
  s_movk_i32 s48, 0x240
  s_cmp_eq_u32 s21, 2
  s_cselect_b32 s49, 0xc0, s48
  s_cselect_b32 s97, 0, 0x180
  s_cselect_b32 s29, 0xc0, 0
  s_mov_b32 s99, 0x1b000
  s_mov_b32 s6, 0xd800
  s_cselect_b32 s74, 0x4800, 0
  s_cselect_b32 s99, 0x1f800, s99
  s_cselect_b32 s6, 0x4800, s6
  v_mad_u32_u24 v27, v8, s48, v11
  v_mad_u32_u24 v14, v8, s49, v11
  v_mad_u32_u24 v28, v9, s48, v12
  v_mad_u32_u24 v15, v9, s49, v12
  v_mad_u32_u24 v29, v10, s48, v13
  v_mad_u32_u24 v16, v10, s49, v13
  s_lshl_b32 s98, s49, 4
  s_movk_i32 s3, 0x2400
  s_mov_b32 s18, 0xd800
  s_mov_b32 s19, 0x20000
  s_mov_b32 s7, 0x20000
  s_lshl_b32 s49, s21, 6
  v_add_u32 v40, s49, v0
  v_mul_u32_u24 v41, 0x1556, v40
  v_lshrrev_b32 v41, 16, v41
  v_mul_u32_u24 v42, 12, v41
  v_sub_u32 v42, v40, v42
  v_and_b32 v43, 3, v41
  v_lshrrev_b32 v44, 2, v41
  v_xor_b32 v45, v42, v43
  s_mov_b32 s48, 0x930000
  v_mul_lo_u32 v43, v43, s48
  v_mul_u32_u24 v44, 0x540, v44
  v_add_u32 v43, v43, v44
  v_lshl_add_u32 v43, v45, 4, v43
  v_add_u32 v39, 0x3f480, v43
  v_and_b32 v25, 31, v0
  v_lshrrev_b32 v26, 5, v0
  v_bfe_u32 v8, v25, 2, 1
  v_lshrrev_b32 v9, 3, v25
  v_and_b32 v10, 3, v25
  v_lshl_add_u32 v11, v9, 2, v10
  v_lshl_add_u32 v12, v8, 4, v11
  v_mul_u32_u24 v12, 0xc0, v12
  v_xor_b32 v13, v26, v9
  v_lshl_add_u32 v20, v13, 4, v12
  v_bfe_u32 v12, v25, 2, 2
  v_xor_b32 v12, v12, v26
  v_mul_u32_u24 v13, 0xc0, v25
  v_lshl_add_u32 v21, v12, 4, v13
  v_lshl_add_u32 v12, v26, 5, v11
  v_lshlrev_b32 v12, 4, v12
  v_mul_u32_u24 v13, 0xc00, v8
  v_add_u32 v23, v12, v13
  v_and_b32 v12, 19, v25
  v_lshl_add_u32 v12, v8, 3, v12
  v_and_b32 v13, 1, v9
  v_lshl_add_u32 v12, v13, 2, v12
  v_lshlrev_b32 v12, 4, v12
  v_lshl_add_u32 v24, v26, 10, v12
  v_bfe_u32 v8, v0, 2, 2
  v_lshl_add_u32 v8, v26, 3, v8
  v_mul_u32_u24 v8, 0xc0, v8
  v_bfe_u32 v9, v0, 4, 1
  v_bfe_u32 v10, v0, 1, 1
  v_lshl_add_u32 v9, v9, 1, v10
  v_lshlrev_b32 v10, 1, v26
  v_xor_b32 v9, v9, v10
  v_lshl_add_u32 v8, v9, 4, v8
  v_and_b32 v9, 1, v0
  v_lshl_add_u32 v22, v9, 3, v8
  s_mov_b32 s27, 0x41622adf
  s_mov_b32 s28, 0xbc2aaaab
  s_mov_b32 s30, 0xf0000f
  s_mov_b32 s31, 0xf0000f00
  s_mov_b32 s32, 0x22222222
  s_mov_b32 s33, 0x22222222
  s_mov_b32 s34, 0x44444444
  s_mov_b32 s35, 0x44444444
  s_mov_b32 s36, 0x88888888
  s_mov_b32 s37, 0x88888888
  s_mov_b32 s38, 0
  s_mov_b32 s39, -1
  s_mov_b32 s40, 0xffff0000
  s_mov_b32 s41, 0xffff0000
  s_mul_i32 s49, s21, 0x900
  s_add_u32 s49, s49, 0x25c00
  v_lshlrev_b32 v46, 4, v0
  v_add_u32 v47, s49, v46
  v_mov_b32 v48, v30
  v_mov_b32 v49, v31
  v_mov_b32 v50, v32
  v_mov_b32 v51, v33
  ds_write_b128 v47, v[48:51]
  v_mov_b32 v52, v34
  v_mov_b32 v53, v35
  v_mov_b32 v54, v36
  v_mov_b32 v55, v37
  ds_write_b128 v47, v[52:55] offset:1024
  s_add_u32 s43, s49, 0x800
  v_lshlrev_b32 v47, 2, v0
  v_add_u32 v47, s43, v47
  ds_write_b32 v47, v38
  s_sub_u32 s42, s49, 0x9000
  v_and_b32 v56, 31, v0
  v_lshrrev_b32 v57, 5, v0
  v_add_u32 v7, 0x9000, v46
  v_bfe_u32 v58, v56, 2, 2
  v_xor_b32 v58, s21, v58
  v_xor_b32 v58, v58, v57
  v_mul_u32_u24 v59, 0xc0, v56
  v_lshl_add_u32 v59, v58, 4, v59
  s_add_u32 s49, s50, 0x12000
  v_add_u32 v1, s49, v59
  v_xor_b32 v58, s21, v57
  v_lshlrev_b32 v58, 4, v58
  s_mul_i32 s49, s21, 0xc0
  s_add_u32 s49, s49, 0x24000
  v_add_u32 v2, s49, v58
  s_lshl_b32 s49, s21, 8
  s_add_u32 s49, s49, 0x24c00
  v_lshlrev_b32 v58, 4, v57
  v_add_u32 v3, s49, v58
  v_lshlrev_b32 v58, 2, v56
  v_add_u32 v4, s49, v58
  v_add_u32 v58, 32, v56
  v_min_u32 v58, 48, v58
  v_lshlrev_b32 v58, 2, v58
  v_add_u32 v6, s49, v58
  v_min_u32 v58, 11, v0
  v_lshlrev_b32 v58, 4, v58
  s_mul_i32 s49, s21, 0xc0
  s_add_u32 s49, s49, 0x24000
  v_add_u32 v5, s49, v58
  s_sub_u32 s73, s50, 0x9000
  s_cmp_eq_u32 s20, 7
  s_cselect_b32 s60, 1, 2
  s_mov_b32 s65, 2
  s_movk_i32 s63, 0x400
  s_movk_i32 s64, 0x100
  s_mul_i32 s62, s60, 0x1800
  s_mov_b32 s48, 0x9000
  s_cmp_eq_u32 s65, 2
  s_cselect_b32 s48, 0xd800, s48
  s_add_u32 s62, s62, s48
  s_cmp_eq_u32 s21, 2
  s_waitcnt lgkmcnt(0)
  s_cselect_b32 s4, s88, s86
  s_cselect_b32 s5, s89, s87
  s_mov_b32 s16, s86
  s_mov_b32 s17, s87
  s_mov_b32 s8, s80
  s_mov_b32 s9, s81
  s_mov_b32 s10, 0x24c0000
  s_mov_b32 s11, 0x20000
  s_mov_b32 s12, s90
  s_mov_b32 s13, s91
  s_mov_b32 s14, 0x24c0000
  s_mov_b32 s15, 0x20000
  s_mov_b32 s68, s80
  s_mov_b32 s69, s81
  s_mov_b32 s70, 0x24c0000
  s_mov_b32 s71, 0x20000
  s_mov_b32 s76, s90
  s_mov_b32 s77, s91
  s_mov_b32 s78, 0x24c0000
  s_mov_b32 s79, 0x20000
  s_sub_u32 s48, s20, 5
  s_cmp_lt_u32 s48, 2
  s_cbranch_scc1 RAW_S
  s_add_u32 m0, s44, 0
  s_nop 0
  buffer_load_dwordx4 v30, s[8:11], s23 offen nt lds
  s_add_u32 m0, s44, 0x400
  s_nop 0
  buffer_load_dwordx4 v31, s[8:11], s23 offen nt lds
  s_add_u32 m0, s44, 0x800
  s_nop 0
  buffer_load_dwordx4 v32, s[8:11], s23 offen nt lds
  s_add_u32 m0, s44, 0xc00
  s_nop 0
  buffer_load_dwordx4 v33, s[8:11], s23 offen nt lds
  s_add_u32 m0, s44, 0x1000
  s_nop 0
  buffer_load_dwordx4 v34, s[8:11], s23 offen nt lds
  s_add_u32 m0, s44, 0x1400
  s_nop 0
  buffer_load_dwordx4 v35, s[8:11], s23 offen nt lds
  s_add_u32 m0, s44, 0x1800
  s_nop 0
  buffer_load_dwordx4 v36, s[8:11], s23 offen nt lds
  s_add_u32 m0, s44, 0x1c00
  s_nop 0
  buffer_load_dwordx4 v37, s[8:11], s23 offen nt lds
  s_add_u32 m0, s44, 0x2000
  s_nop 0
  buffer_load_dwordx4 v38, s[8:11], s23 offen nt lds
  s_add_u32 s23, s23, 0x540
  s_cmp_ge_u32 s21, 3
  s_cbranch_scc1 S_NOEXT
  s_lshl_b32 s49, s21, 10
  s_add_u32 m0, s49, 0x24000
  s_nop 0
  buffer_load_dwordx4 v39, s[8:11], s22 offen lds
S_NOEXT:
  s_barrier
  s_cmp_eq_u32 s20, 7
  s_cbranch_scc1 FOLD_B
  s_branch FOLD_B3
RAW_S:
  s_add_u32 m0, s74, 0
  s_nop 0
  buffer_load_dwordx4 v27, s[16:19], s29 offen lds
  s_add_u32 m0, s74, 0x400
  s_nop 0
  buffer_load_dwordx4 v28, s[16:19], s29 offen lds
  s_add_u32 m0, s74, 0x800
  s_nop 0
  buffer_load_dwordx4 v29, s[16:19], s29 offen lds
  s_add_u32 s29, s29, s3
  s_add_u32 m0, s74, 0xc00
  s_nop 0
  buffer_load_dwordx4 v27, s[16:19], s29 offen lds
  s_add_u32 m0, s74, 0x1000
  s_nop 0
  buffer_load_dwordx4 v28, s[16:19], s29 offen lds
  s_add_u32 m0, s74, 0x1400
  s_nop 0
  buffer_load_dwordx4 v29, s[16:19], s29 offen lds
  s_add_u32 s29, s29, s3
  s_add_u32 m0, s74, 0x1800
  s_nop 0
  buffer_load_dwordx4 v27, s[16:19], s29 offen lds
  s_add_u32 m0, s74, 0x1c00
  s_nop 0
  buffer_load_dwordx4 v28, s[16:19], s29 offen lds
  s_add_u32 m0, s74, 0x2000
  s_nop 0
  buffer_load_dwordx4 v29, s[16:19], s29 offen lds
  s_add_u32 s29, s29, s3
  s_add_u32 m0, s74, 0x2400
  s_nop 0
  buffer_load_dwordx4 v27, s[16:19], s29 offen lds
  s_add_u32 m0, s74, 0x2800
  s_nop 0
  buffer_load_dwordx4 v28, s[16:19], s29 offen lds
  s_add_u32 m0, s74, 0x2c00
  s_nop 0
  buffer_load_dwordx4 v29, s[16:19], s29 offen lds
  s_add_u32 s29, s29, s3
  s_add_u32 m0, s74, 0x3000
  s_nop 0
  buffer_load_dwordx4 v27, s[16:19], s29 offen lds
  s_add_u32 m0, s74, 0x3400
  s_nop 0
  buffer_load_dwordx4 v28, s[16:19], s29 offen lds
  s_add_u32 m0, s74, 0x3800
  s_nop 0
  buffer_load_dwordx4 v29, s[16:19], s29 offen lds
  s_add_u32 s29, s29, s3
  s_add_u32 m0, s74, 0x3c00
  s_nop 0
  buffer_load_dwordx4 v27, s[16:19], s29 offen lds
  s_add_u32 m0, s74, 0x4000
  s_nop 0
  buffer_load_dwordx4 v28, s[16:19], s29 offen lds
  s_add_u32 m0, s74, 0x4400
  s_nop 0
  buffer_load_dwordx4 v29, s[16:19], s29 offen lds
  s_barrier
  s_add_u32 m0, s44, 0
  s_nop 0
  buffer_load_dwordx4 v30, s[8:11], s23 offen nt lds
  s_add_u32 m0, s44, 0x400
  s_nop 0
  buffer_load_dwordx4 v31, s[8:11], s23 offen nt lds
  s_add_u32 m0, s44, 0x800
  s_nop 0
  buffer_load_dwordx4 v32, s[8:11], s23 offen nt lds
  s_add_u32 m0, s44, 0xc00
  s_nop 0
  buffer_load_dwordx4 v33, s[8:11], s23 offen nt lds
  s_add_u32 m0, s44, 0x1000
  s_nop 0
  buffer_load_dwordx4 v34, s[8:11], s23 offen nt lds
  s_add_u32 m0, s44, 0x1400
  s_nop 0
  buffer_load_dwordx4 v35, s[8:11], s23 offen nt lds
  s_add_u32 m0, s44, 0x1800
  s_nop 0
  buffer_load_dwordx4 v36, s[8:11], s23 offen nt lds
  s_add_u32 m0, s44, 0x1c00
  s_nop 0
  buffer_load_dwordx4 v37, s[8:11], s23 offen nt lds
  s_add_u32 m0, s44, 0x2000
  s_nop 0
  buffer_load_dwordx4 v38, s[8:11], s23 offen nt lds
  s_add_u32 s23, s23, 0x540
  s_lshl_b32 s49, s21, 10
  s_add_u32 m0, s49, 0x24000
  s_nop 0
  buffer_load_dwordx4 v39, s[8:11], s22 offen lds
FOLD_B3:
  s_setprio 2
  v_add_u32 v10, 0x1f880, v22
  s_mul_i32 s48, s21, 0x1800
  v_xor_b32 v11, 16, v10
  s_add_u32 s48, s48, 0x1b000
  ds_read_b64_tr_b16 v[176:177], v10 offset:0
  v_add_u32 v8, s48, v20
  v_add_u32 v11, 0x300, v11
  ds_read_b128 v[224:227], v8 offset:0
  ds_read_b64_tr_b16 v[178:179], v11 offset:0
  v_xor_b32 v9, 32, v8
  ds_read_b64_tr_b16 v[180:181], v10 offset:3072
  ds_read_b64_tr_b16 v[182:183], v11 offset:3072
  ds_read_b128 v[228:231], v9 offset:0
  ds_read_b64_tr_b16 v[184:185], v10 offset:6144
  ds_read_b64_tr_b16 v[186:187], v11 offset:6144
  ds_read_b128 v[232:235], v8 offset:64
  ds_read_b64_tr_b16 v[188:189], v10 offset:9216
  ds_read_b64_tr_b16 v[190:191], v11 offset:9216
  ds_read_b128 v[236:239], v9 offset:64
  ds_read_b64_tr_b16 v[192:193], v10 offset:12288
  ds_read_b64_tr_b16 v[194:195], v11 offset:12288
  ds_read_b128 v[240:243], v8 offset:128
  ds_read_b64_tr_b16 v[196:197], v10 offset:15360
  ds_read_b64_tr_b16 v[198:199], v11 offset:15360
  ds_read_b128 v[244:247], v9 offset:128
  s_lshl_b32 s49, s21, 8
  v_lshlrev_b32 v10, 2, v25
  s_add_u32 s49, s49, 0x25880
  v_add_u32 v10, 0x25880, v10
  s_lshl_b32 s48, s21, 10
  v_lshl_add_u32 v12, v25, 2, s49
  s_add_u32 s48, s48, s62
  v_add_u32 v8, s48, v23
  v_add_u32 v9, 0x100, v8
  s_waitcnt lgkmcnt(15)
  v_mfma_f32_32x32x16_bf16 v[112:127], v[224:227], v[176:179], 0
  s_waitcnt lgkmcnt(12)
  v_mfma_f32_32x32x16_bf16 v[112:127], v[228:231], v[180:183], v[112:127]
  s_waitcnt lgkmcnt(9)
  v_mfma_f32_32x32x16_bf16 v[112:127], v[232:235], v[184:187], v[112:127]
  s_waitcnt lgkmcnt(6)
  v_mfma_f32_32x32x16_bf16 v[112:127], v[236:239], v[188:191], v[112:127]
  s_waitcnt lgkmcnt(3)
  v_mfma_f32_32x32x16_bf16 v[112:127], v[240:243], v[192:195], v[112:127]
  s_waitcnt lgkmcnt(0)
  v_mfma_f32_32x32x16_bf16 v[112:127], v[244:247], v[196:199], v[112:127]
  s_nop 11
  v_add_f32 v128, v112, v113
  v_add_f32 v129, v114, v115
  v_add_f32 v128, v128, v116
  v_add_f32 v129, v129, v117
  v_add_f32 v128, v128, v118
  v_add_f32 v129, v129, v119
  v_add_f32 v128, v128, v120
  v_add_f32 v129, v129, v121
  v_add_f32 v128, v128, v122
  v_add_f32 v129, v129, v123
  v_add_f32 v128, v128, v124
  v_add_f32 v129, v129, v125
  v_add_f32 v128, v128, v126
  v_add_f32 v129, v129, v127
  v_add_f32 v128, v128, v129
  v_mov_b32 v129, v128
  s_nop 1
  v_permlane32_swap_b32 v128, v129
  v_add_f32 v128, v128, v129
  ds_write_b32 v12, v128
  s_waitcnt lgkmcnt(0)
  s_barrier
  ds_read_b32 v130, v10 offset:0
  ds_read_b32 v131, v10 offset:256
  ds_read_b32 v132, v10 offset:512
  s_cmp_eq_u32 s20, 4
  s_cbranch_scc1 FOLD_B3b
  s_add_u32 m0, s99, 0
  s_nop 0
  buffer_load_dwordx4 v14, s[4:7], s97 offen lds
  s_add_u32 m0, s99, 0x400
  s_nop 0
  buffer_load_dwordx4 v15, s[4:7], s97 offen lds
  s_add_u32 m0, s99, 0x800
  s_nop 0
  buffer_load_dwordx4 v16, s[4:7], s97 offen lds
  s_add_u32 s97, s97, s98
  s_add_u32 m0, s99, 0xc00
  s_nop 0
  buffer_load_dwordx4 v14, s[4:7], s97 offen lds
  s_add_u32 m0, s99, 0x1000
  s_nop 0
  buffer_load_dwordx4 v15, s[4:7], s97 offen lds
  s_add_u32 m0, s99, 0x1400
  s_nop 0
  buffer_load_dwordx4 v16, s[4:7], s97 offen lds
  s_add_u32 s97, s97, s98
  s_add_u32 m0, s99, 0x1800
  s_nop 0
  buffer_load_dwordx4 v14, s[4:7], s97 offen lds
  s_add_u32 m0, s99, 0x1c00
  s_nop 0
  buffer_load_dwordx4 v15, s[4:7], s97 offen lds
  s_add_u32 m0, s99, 0x2000
  s_nop 0
  buffer_load_dwordx4 v16, s[4:7], s97 offen lds
  s_add_u32 s97, s97, s98
  s_add_u32 m0, s99, 0x2400
  s_nop 0
  buffer_load_dwordx4 v14, s[4:7], s97 offen lds
  s_add_u32 m0, s99, 0x2800
  s_nop 0
  buffer_load_dwordx4 v15, s[4:7], s97 offen lds
  s_add_u32 m0, s99, 0x2c00
  s_nop 0
  buffer_load_dwordx4 v16, s[4:7], s97 offen lds
  s_add_u32 s97, s97, s98
  s_add_u32 m0, s99, 0x3000
  s_nop 0
  buffer_load_dwordx4 v14, s[4:7], s97 offen lds
  s_add_u32 m0, s99, 0x3400
  s_nop 0
  buffer_load_dwordx4 v15, s[4:7], s97 offen lds
  s_add_u32 m0, s99, 0x3800
  s_nop 0
  buffer_load_dwordx4 v16, s[4:7], s97 offen lds
  s_add_u32 s97, s97, s98
  s_add_u32 m0, s99, 0x3c00
  s_nop 0
  buffer_load_dwordx4 v14, s[4:7], s97 offen lds
  s_add_u32 m0, s99, 0x4000
  s_nop 0
  buffer_load_dwordx4 v15, s[4:7], s97 offen lds
  s_add_u32 m0, s99, 0x4400
  s_nop 0
  buffer_load_dwordx4 v16, s[4:7], s97 offen lds
FOLD_B3b:
  s_waitcnt lgkmcnt(0)
  v_add_f32 v130, v130, v131
  v_add_f32 v130, v130, v132
  v_mul_f32 v130, 0xbdd105ec, v130
  s_mov_b32 s48, 0x411cc471
  v_fma_f32 v112, v112, s48, v130
  v_fma_f32 v113, v113, s48, v130
  v_fma_f32 v114, v114, s48, v130
  v_fma_f32 v115, v115, s48, v130
  v_fma_f32 v116, v116, s48, v130
  v_fma_f32 v117, v117, s48, v130
  v_fma_f32 v118, v118, s48, v130
  v_fma_f32 v119, v119, s48, v130
  v_fma_f32 v120, v120, s48, v130
  v_fma_f32 v121, v121, s48, v130
  v_fma_f32 v122, v122, s48, v130
  v_fma_f32 v123, v123, s48, v130
  v_fma_f32 v124, v124, s48, v130
  v_fma_f32 v125, v125, s48, v130
  v_fma_f32 v126, v126, s48, v130
  v_fma_f32 v127, v127, s48, v130
  v_cvt_pk_bf16_f32 v176, v112, v113
  v_cvt_pk_bf16_f32 v177, v114, v115
  v_cvt_pk_bf16_f32 v178, v116, v117
  v_cvt_pk_bf16_f32 v179, v118, v119
  v_cvt_pk_bf16_f32 v180, v120, v121
  v_cvt_pk_bf16_f32 v181, v122, v123
  v_cvt_pk_bf16_f32 v182, v124, v125
  v_cvt_pk_bf16_f32 v183, v126, v127
  ds_write_b128 v8, v[176:179]
  ds_write_b128 v9, v[180:183]
  s_branch FOLD_DONE_T
JOIN:
  v_and_b32 v25, 31, v0
  v_lshrrev_b32 v26, 5, v0
  v_bfe_u32 v8, v25, 2, 1
  v_lshrrev_b32 v9, 3, v25
  v_and_b32 v10, 3, v25
  v_lshl_add_u32 v11, v9, 2, v10
  v_lshl_add_u32 v12, v8, 4, v11
  v_mul_u32_u24 v12, 0xc0, v12
  v_xor_b32 v13, v26, v9
  v_lshl_add_u32 v20, v13, 4, v12
  v_bfe_u32 v12, v25, 2, 2
  v_xor_b32 v12, v12, v26
  v_mul_u32_u24 v13, 0xc0, v25
  v_lshl_add_u32 v21, v12, 4, v13
  v_lshl_add_u32 v12, v26, 5, v11
  v_lshlrev_b32 v12, 4, v12
  v_mul_u32_u24 v13, 0xc00, v8
  v_add_u32 v23, v12, v13
  v_and_b32 v12, 19, v25
  v_lshl_add_u32 v12, v8, 3, v12
  v_and_b32 v13, 1, v9
  v_lshl_add_u32 v12, v13, 2, v12
  v_lshlrev_b32 v12, 4, v12
  v_lshl_add_u32 v24, v26, 10, v12
  v_bfe_u32 v8, v0, 2, 2
  v_lshl_add_u32 v8, v26, 3, v8
  v_mul_u32_u24 v8, 0xc0, v8
  v_bfe_u32 v9, v0, 4, 1
  v_bfe_u32 v10, v0, 1, 1
  v_lshl_add_u32 v9, v9, 1, v10
  v_lshlrev_b32 v10, 1, v26
  v_xor_b32 v9, v9, v10
  v_lshl_add_u32 v8, v9, 4, v8
  v_and_b32 v9, 1, v0
  v_lshl_add_u32 v22, v9, 3, v8
  s_movk_i32 s63, 0x400
  s_movk_i32 s64, 0x100
  s_mul_i32 s62, s60, 0x1800
  s_mov_b32 s48, 0x9000
  s_cmp_eq_u32 s65, 2
  s_cselect_b32 s48, 0xd800, s48
  s_add_u32 s62, s62, s48
  s_waitcnt vmcnt(0) lgkmcnt(0)
  s_barrier
  s_cmp_eq_u32 s65, 2
  s_cbranch_scc1 FOLD_B
FOLD_A:
  s_mul_i32 s48, s60, 0x1800
  v_add_u32 v8, 0x9000, v20
  s_add_u32 s48, s48, 0x9000
  ds_read_b128 v[224:227], v8 offset:18432
  v_add_u32 v10, s48, v21
  v_xor_b32 v9, 32, v8
  ds_read_b128 v[200:203], v10 offset:0
  v_xor_b32 v11, 32, v10
  ds_read_b128 v[228:231], v9 offset:18432
  ds_read_b128 v[204:207], v11 offset:0
  ds_read_b128 v[208:211], v10 offset:64
  ds_read_b128 v[232:235], v8 offset:18496
  ds_read_b128 v[212:215], v11 offset:64
  ds_read_b128 v[236:239], v9 offset:18496
  ds_read_b128 v[216:219], v10 offset:128
  ds_read_b128 v[240:243], v8 offset:18560
  ds_read_b128 v[220:223], v11 offset:128
  ds_read_b128 v[244:247], v9 offset:18560
  ds_read_b128 v[248:251], v8 offset:24576
  ds_read_b128 v[252:255], v9 offset:24576
  ds_read_b128 v[176:179], v10 offset:18432
  ds_read_b128 v[180:183], v11 offset:18432
  ds_read_b128 v[184:187], v10 offset:18496
  ds_read_b128 v[188:191], v11 offset:18496
  ds_read_b128 v[192:195], v10 offset:18560
  ds_read_b128 v[196:199], v11 offset:18560
  s_lshl_b32 s49, s60, 8
  s_add_u32 s49, s49, 0x25800
  v_lshl_add_u32 v12, v25, 2, s49
  s_waitcnt lgkmcnt(15)
  v_mfma_f32_32x32x16_bf16 v[160:175], v[224:227], v[200:203], 0
  ds_read_b128 v[224:227], v8 offset:24640
  v_mfma_f32_32x32x16_bf16 v[160:175], v[228:231], v[204:207], v[160:175]
  ds_read_b128 v[228:231], v9 offset:24640
  s_waitcnt lgkmcnt(15)
  v_mfma_f32_32x32x16_bf16 v[160:175], v[232:235], v[208:211], v[160:175]
  ds_read_b128 v[232:235], v8 offset:24704
  s_waitcnt lgkmcnt(15)
  v_mfma_f32_32x32x16_bf16 v[160:175], v[236:239], v[212:215], v[160:175]
  ds_read_b128 v[236:239], v9 offset:24704
  s_waitcnt lgkmcnt(14)
  v_mfma_f32_32x32x16_bf16 v[160:175], v[240:243], v[216:219], v[160:175]
  ds_read_b128 v[240:243], v8 offset:30720
  s_waitcnt lgkmcnt(13)
  v_mfma_f32_32x32x16_bf16 v[160:175], v[244:247], v[220:223], v[160:175]
  ds_read_b128 v[244:247], v9 offset:30720
  s_waitcnt lgkmcnt(13)
  v_mfma_f32_32x32x16_bf16 v[160:175], v[248:251], v[200:203], v[160:175]
  ds_read_b128 v[248:251], v8 offset:30784
  s_waitcnt lgkmcnt(13)
  v_mfma_f32_32x32x16_bf16 v[160:175], v[252:255], v[204:207], v[160:175]
  ds_read_b128 v[252:255], v9 offset:30784
  s_waitcnt lgkmcnt(7)
  v_mfma_f32_32x32x16_bf16 v[160:175], v[224:227], v[208:211], v[160:175]
  ds_read_b128 v[224:227], v8 offset:30848
  s_waitcnt lgkmcnt(7)
  v_mfma_f32_32x32x16_bf16 v[160:175], v[228:231], v[212:215], v[160:175]
  ds_read_b128 v[228:231], v9 offset:30848
  s_waitcnt lgkmcnt(7)
  v_mfma_f32_32x32x16_bf16 v[160:175], v[232:235], v[216:219], v[160:175]
  ds_read_b128 v[232:235], v8 offset:0
  s_waitcnt lgkmcnt(7)
  v_mfma_f32_32x32x16_bf16 v[160:175], v[236:239], v[220:223], v[160:175]
  ds_read_b128 v[236:239], v9 offset:0
  s_waitcnt lgkmcnt(7)
  v_mfma_f32_32x32x16_bf16 v[160:175], v[240:243], v[200:203], v[160:175]
  ds_read_b128 v[240:243], v8 offset:64
  s_waitcnt lgkmcnt(7)
  v_mfma_f32_32x32x16_bf16 v[160:175], v[244:247], v[204:207], v[160:175]
  ds_read_b128 v[244:247], v9 offset:64
  s_waitcnt lgkmcnt(3)
  v_mfma_f32_32x32x16_bf16 v[112:127], v[232:235], v[176:179], 0
  ds_read_b128 v[232:235], v8 offset:6208
  v_mfma_f32_32x32x16_bf16 v[160:175], v[248:251], v[208:211], v[160:175]
  ds_read_b128 v[248:251], v8 offset:128
  s_waitcnt lgkmcnt(4)
  v_mfma_f32_32x32x16_bf16 v[112:127], v[236:239], v[180:183], v[112:127]
  ds_read_b128 v[236:239], v9 offset:6208
  v_mfma_f32_32x32x16_bf16 v[160:175], v[252:255], v[212:215], v[160:175]
  ds_read_b128 v[252:255], v9 offset:128
  s_waitcnt lgkmcnt(5)
  v_mfma_f32_32x32x16_bf16 v[112:127], v[240:243], v[184:187], v[112:127]
  ds_read_b128 v[240:243], v8 offset:6272
  v_mfma_f32_32x32x16_bf16 v[160:175], v[224:227], v[216:219], v[160:175]
  ds_read_b128 v[224:227], v8 offset:6144
  s_waitcnt lgkmcnt(6)
  v_mfma_f32_32x32x16_bf16 v[112:127], v[244:247], v[188:191], v[112:127]
  ds_read_b128 v[244:247], v9 offset:6272
  v_mfma_f32_32x32x16_bf16 v[160:175], v[228:231], v[220:223], v[160:175]
  ds_read_b128 v[228:231], v9 offset:6144
  s_waitcnt lgkmcnt(6)
  v_mfma_f32_32x32x16_bf16 v[112:127], v[248:251], v[192:195], v[112:127]
  ds_read_b128 v[248:251], v8 offset:12288
  s_waitcnt lgkmcnt(5)
  v_mfma_f32_32x32x16_bf16 v[112:127], v[252:255], v[196:199], v[112:127]
  ds_read_b128 v[252:255], v9 offset:12288
  s_nop 4
  v_add_f32 v13, v160, v161
  v_add_f32 v14, v162, v163
  v_add_f32 v13, v13, v164
  v_add_f32 v14, v14, v165
  v_add_f32 v13, v13, v166
  s_waitcnt lgkmcnt(4)
  v_mfma_f32_32x32x16_bf16 v[128:143], v[224:227], v[176:179], 0
  ds_read_b128 v[224:227], v8 offset:12352
  v_add_f32 v14, v14, v167
  v_add_f32 v13, v13, v168
  v_add_f32 v14, v14, v169
  v_add_f32 v13, v13, v170
  v_add_f32 v14, v14, v171
  s_waitcnt lgkmcnt(3)
  v_mfma_f32_32x32x16_bf16 v[128:143], v[228:231], v[180:183], v[128:143]
  ds_read_b128 v[228:231], v9 offset:12352
  v_add_f32 v13, v13, v172
  v_add_f32 v14, v14, v173
  v_add_f32 v13, v13, v174
  v_add_f32 v14, v14, v175
  v_add_f32 v13, v13, v14
  s_waitcnt lgkmcnt(3)
  v_mfma_f32_32x32x16_bf16 v[144:159], v[248:251], v[176:179], 0
  v_mov_b32 v14, v13
  s_nop 1
  v_permlane32_swap_b32 v13, v14
  v_add_f32 v13, v13, v14
  v_mfma_f32_32x32x16_bf16 v[128:143], v[232:235], v[184:187], v[128:143]
  ds_read_b128 v[232:235], v8 offset:12416
  v_mul_f32 v13, 0xbc2aaaab, v13
  ds_write_b32 v12, v13
  s_waitcnt lgkmcnt(4)
  v_mfma_f32_32x32x16_bf16 v[144:159], v[252:255], v[180:183], v[144:159]
  v_mfma_f32_32x32x16_bf16 v[128:143], v[236:239], v[188:191], v[128:143]
  ds_read_b128 v[236:239], v9 offset:12416
  s_waitcnt lgkmcnt(4)
  v_mfma_f32_32x32x16_bf16 v[144:159], v[224:227], v[184:187], v[144:159]
  s_waitcnt lgkmcnt(3)
  v_mfma_f32_32x32x16_bf16 v[144:159], v[228:231], v[188:191], v[144:159]
  v_mfma_f32_32x32x16_bf16 v[128:143], v[240:243], v[192:195], v[128:143]
  s_waitcnt lgkmcnt(2)
  v_mfma_f32_32x32x16_bf16 v[144:159], v[232:235], v[192:195], v[144:159]
  v_mfma_f32_32x32x16_bf16 v[128:143], v[244:247], v[196:199], v[128:143]
  s_waitcnt lgkmcnt(0)
  v_mfma_f32_32x32x16_bf16 v[144:159], v[236:239], v[196:199], v[144:159]
  s_waitcnt lgkmcnt(0)
  s_barrier
FOLD_A2:
  v_lshlrev_b32 v8, 6, v26
  s_mov_b32 s66, 0x3f800000
  s_mov_b32 s67, 0xbc2aaaab
  v_add_u32 v8, 0x25800, v8
  ds_read_b128 v[176:179], v8 offset:0
  ds_read_b128 v[180:183], v8 offset:16
  ds_read_b128 v[184:187], v8 offset:32
  ds_read_b128 v[188:191], v8 offset:48
  ds_read_b128 v[192:195], v8 offset:256
  ds_read_b128 v[196:199], v8 offset:272
  ds_read_b128 v[200:203], v8 offset:288
  ds_read_b128 v[204:207], v8 offset:304
  ds_read_b128 v[208:211], v8 offset:512
  ds_read_b128 v[212:215], v8 offset:528
  ds_read_b128 v[216:219], v8 offset:544
  ds_read_b128 v[220:223], v8 offset:560
  s_waitcnt lgkmcnt(11)
  v_add_f32 v112, v112, v176
  v_add_f32 v113, v113, v177
  v_add_f32 v114, v114, v178
  v_add_f32 v115, v115, v179
  s_waitcnt lgkmcnt(10)
  v_add_f32 v116, v116, v180
  v_add_f32 v117, v117, v181
  v_add_f32 v118, v118, v182
  v_add_f32 v119, v119, v183
  s_waitcnt lgkmcnt(9)
  v_add_f32 v120, v120, v184
  v_add_f32 v121, v121, v185
  v_add_f32 v122, v122, v186
  v_add_f32 v123, v123, v187
  s_waitcnt lgkmcnt(8)
  v_add_f32 v124, v124, v188
  v_add_f32 v125, v125, v189
  v_add_f32 v126, v126, v190
  v_add_f32 v127, v127, v191
  s_waitcnt lgkmcnt(7)
  v_add_f32 v128, v128, v192
  v_add_f32 v129, v129, v193
  v_add_f32 v130, v130, v194
  v_add_f32 v131, v131, v195
  s_waitcnt lgkmcnt(6)
  v_add_f32 v132, v132, v196
  v_add_f32 v133, v133, v197
  v_add_f32 v134, v134, v198
  v_add_f32 v135, v135, v199
  s_waitcnt lgkmcnt(5)
  v_add_f32 v136, v136, v200
  v_add_f32 v137, v137, v201
  v_add_f32 v138, v138, v202
  v_add_f32 v139, v139, v203
  s_waitcnt lgkmcnt(4)
  v_add_f32 v140, v140, v204
  v_add_f32 v141, v141, v205
  v_add_f32 v142, v142, v206
  v_add_f32 v143, v143, v207
  s_waitcnt lgkmcnt(3)
  v_add_f32 v144, v144, v208
  v_add_f32 v145, v145, v209
  v_add_f32 v146, v146, v210
  v_add_f32 v147, v147, v211
  s_waitcnt lgkmcnt(2)
  v_add_f32 v148, v148, v212
  v_add_f32 v149, v149, v213
  v_add_f32 v150, v150, v214
  v_add_f32 v151, v151, v215
  s_waitcnt lgkmcnt(1)
  v_add_f32 v152, v152, v216
  v_add_f32 v153, v153, v217
  v_add_f32 v154, v154, v218
  v_add_f32 v155, v155, v219
  s_waitcnt lgkmcnt(0)
  v_add_f32 v156, v156, v220
  v_add_f32 v157, v157, v221
  v_add_f32 v158, v158, v222
  v_add_f32 v159, v159, v223
  s_branch FOLD_TAIL
FOLD_B:
  s_lshl_b32 s48, s60, 6
  v_add_u32 v8, 0x1b000, v20
  s_add_u32 s48, s48, 0x1f800
  s_mov_b32 s66, 0x411cc471
  v_add_u32 v10, s48, v22
  ds_read_b128 v[224:227], v8 offset:0
  v_xor_b32 v11, 16, v10
  ds_read_b64_tr_b16 v[176:177], v10 offset:0
  v_add_u32 v11, 0x300, v11
  v_xor_b32 v9, 32, v8
  ds_read_b64_tr_b16 v[178:179], v11 offset:0
  ds_read_b64_tr_b16 v[180:181], v10 offset:3072
  ds_read_b64_tr_b16 v[182:183], v11 offset:3072
  ds_read_b128 v[228:231], v9 offset:0
  ds_read_b64_tr_b16 v[184:185], v10 offset:6144
  ds_read_b64_tr_b16 v[186:187], v11 offset:6144
  ds_read_b128 v[232:235], v8 offset:64
  ds_read_b64_tr_b16 v[188:189], v10 offset:9216
  ds_read_b64_tr_b16 v[190:191], v11 offset:9216
  ds_read_b128 v[236:239], v9 offset:64
  ds_read_b64_tr_b16 v[192:193], v10 offset:12288
  ds_read_b64_tr_b16 v[194:195], v11 offset:12288
  ds_read_b128 v[240:243], v8 offset:128
  ds_read_b64_tr_b16 v[196:197], v10 offset:15360
  ds_read_b64_tr_b16 v[198:199], v11 offset:15360
  ds_read_b128 v[244:247], v9 offset:128
  ds_read_b128 v[248:251], v8 offset:6144
  ds_read_b128 v[252:255], v9 offset:6144
  s_mov_b32 s67, 0xbdd105ec
  s_waitcnt lgkmcnt(15)
  v_mfma_f32_32x32x16_bf16 v[112:127], v[224:227], v[176:179], 0
  ds_read_b128 v[224:227], v8 offset:6208
  s_waitcnt lgkmcnt(15)
  v_mfma_f32_32x32x16_bf16 v[112:127], v[228:231], v[180:183], v[112:127]
  ds_read_b128 v[228:231], v9 offset:6208
  s_waitcnt lgkmcnt(13)
  v_mfma_f32_32x32x16_bf16 v[112:127], v[232:235], v[184:187], v[112:127]
  ds_read_b128 v[232:235], v8 offset:6272
  s_waitcnt lgkmcnt(4)
  v_mfma_f32_32x32x16_bf16 v[128:143], v[248:251], v[176:179], 0
  ds_read_b128 v[248:251], v8 offset:12352
  v_mfma_f32_32x32x16_bf16 v[112:127], v[236:239], v[188:191], v[112:127]
  ds_read_b128 v[236:239], v9 offset:6272
  v_mfma_f32_32x32x16_bf16 v[112:127], v[240:243], v[192:195], v[112:127]
  ds_read_b128 v[240:243], v8 offset:12288
  v_mfma_f32_32x32x16_bf16 v[112:127], v[244:247], v[196:199], v[112:127]
  ds_read_b128 v[244:247], v9 offset:12288
  s_waitcnt lgkmcnt(7)
  v_mfma_f32_32x32x16_bf16 v[128:143], v[252:255], v[180:183], v[128:143]
  ds_read_b128 v[252:255], v9 offset:12352
  s_waitcnt lgkmcnt(7)
  v_mfma_f32_32x32x16_bf16 v[128:143], v[224:227], v[184:187], v[128:143]
  ds_read_b128 v[224:227], v8 offset:12416
  s_waitcnt lgkmcnt(3)
  v_mfma_f32_32x32x16_bf16 v[144:159], v[240:243], v[176:179], 0
  s_waitcnt lgkmcnt(2)
  v_mfma_f32_32x32x16_bf16 v[144:159], v[244:247], v[180:183], v[144:159]
  v_mfma_f32_32x32x16_bf16 v[128:143], v[228:231], v[188:191], v[128:143]
  ds_read_b128 v[228:231], v9 offset:12416
  v_mfma_f32_32x32x16_bf16 v[144:159], v[248:251], v[184:187], v[144:159]
  s_waitcnt lgkmcnt(2)
  v_mfma_f32_32x32x16_bf16 v[144:159], v[252:255], v[188:191], v[144:159]
  v_mfma_f32_32x32x16_bf16 v[128:143], v[232:235], v[192:195], v[128:143]
  s_waitcnt lgkmcnt(1)
  v_mfma_f32_32x32x16_bf16 v[144:159], v[224:227], v[192:195], v[144:159]
  v_mfma_f32_32x32x16_bf16 v[128:143], v[236:239], v[196:199], v[128:143]
  s_waitcnt lgkmcnt(0)
  v_mfma_f32_32x32x16_bf16 v[144:159], v[228:231], v[196:199], v[144:159]
  s_barrier
  s_nop 15
  v_add_f32 v14, v112, v116
  v_add_f32 v15, v113, v117
  v_add_f32 v16, v114, v118
  v_add_f32 v17, v115, v119
  v_add_f32 v14, v14, v120
  v_add_f32 v15, v15, v121
  v_add_f32 v16, v16, v122
  v_add_f32 v17, v17, v123
  v_add_f32 v14, v14, v124
  v_add_f32 v15, v15, v125
  v_add_f32 v16, v16, v126
  v_add_f32 v17, v17, v127
  v_add_f32 v14, v14, v128
  v_add_f32 v15, v15, v129
  v_add_f32 v16, v16, v130
  v_add_f32 v17, v17, v131
  v_add_f32 v14, v14, v132
  v_add_f32 v15, v15, v133
  v_add_f32 v16, v16, v134
  v_add_f32 v17, v17, v135
  v_add_f32 v14, v14, v136
  v_add_f32 v15, v15, v137
  v_add_f32 v16, v16, v138
  v_add_f32 v17, v17, v139
  v_add_f32 v14, v14, v140
  v_add_f32 v15, v15, v141
  v_add_f32 v16, v16, v142
  v_add_f32 v17, v17, v143
  v_add_f32 v14, v14, v144
  v_add_f32 v15, v15, v145
  v_add_f32 v16, v16, v146
  v_add_f32 v17, v17, v147
  v_add_f32 v14, v14, v148
  v_add_f32 v15, v15, v149
  v_add_f32 v16, v16, v150
  v_add_f32 v17, v17, v151
  v_add_f32 v14, v14, v152
  v_add_f32 v15, v15, v153
  v_add_f32 v16, v16, v154
  v_add_f32 v17, v17, v155
  v_add_f32 v14, v14, v156
  v_add_f32 v15, v15, v157
  v_add_f32 v16, v16, v158
  v_add_f32 v17, v17, v159
  v_add_f32 v14, v14, v15
  v_add_f32 v16, v16, v17
  v_add_u32 v8, s62, v23
  v_add_f32 v14, v14, v16
  v_add_u32 v9, s64, v8
  v_mov_b32 v15, v14
  v_add_u32 v10, s63, v8
  v_add_u32 v11, s63, v9
  v_permlane32_swap_b32 v14, v15
  v_add_f32 v14, v14, v15
  v_add_u32 v12, s63, v10
  v_mul_f32 v14, s67, v14
  v_add_u32 v13, s63, v11
  v_fma_f32 v112, v112, s66, v14
  v_fma_f32 v113, v113, s66, v14
  v_fma_f32 v114, v114, s66, v14
  v_fma_f32 v115, v115, s66, v14
  v_fma_f32 v116, v116, s66, v14
  v_fma_f32 v117, v117, s66, v14
  v_fma_f32 v118, v118, s66, v14
  v_fma_f32 v119, v119, s66, v14
  v_fma_f32 v120, v120, s66, v14
  v_fma_f32 v121, v121, s66, v14
  v_fma_f32 v122, v122, s66, v14
  v_fma_f32 v123, v123, s66, v14
  v_fma_f32 v124, v124, s66, v14
  v_fma_f32 v125, v125, s66, v14
  v_fma_f32 v126, v126, s66, v14
  v_fma_f32 v127, v127, s66, v14
  v_fma_f32 v128, v128, s66, v14
  v_fma_f32 v129, v129, s66, v14
  v_fma_f32 v130, v130, s66, v14
  v_fma_f32 v131, v131, s66, v14
  v_fma_f32 v132, v132, s66, v14
  v_fma_f32 v133, v133, s66, v14
  v_fma_f32 v134, v134, s66, v14
  v_fma_f32 v135, v135, s66, v14
  v_fma_f32 v136, v136, s66, v14
  v_fma_f32 v137, v137, s66, v14
  v_fma_f32 v138, v138, s66, v14
  v_fma_f32 v139, v139, s66, v14
  v_fma_f32 v140, v140, s66, v14
  v_fma_f32 v141, v141, s66, v14
  v_fma_f32 v142, v142, s66, v14
  v_fma_f32 v143, v143, s66, v14
  v_fma_f32 v144, v144, s66, v14
  v_fma_f32 v145, v145, s66, v14
  v_fma_f32 v146, v146, s66, v14
  v_fma_f32 v147, v147, s66, v14
  v_fma_f32 v148, v148, s66, v14
  v_fma_f32 v149, v149, s66, v14
  v_fma_f32 v150, v150, s66, v14
  v_fma_f32 v151, v151, s66, v14
  v_fma_f32 v152, v152, s66, v14
  v_fma_f32 v153, v153, s66, v14
  v_fma_f32 v154, v154, s66, v14
  v_fma_f32 v155, v155, s66, v14
  v_fma_f32 v156, v156, s66, v14
  v_fma_f32 v157, v157, s66, v14
  v_fma_f32 v158, v158, s66, v14
  v_fma_f32 v159, v159, s66, v14
  v_cvt_pk_bf16_f32 v176, v112, v113
  v_cvt_pk_bf16_f32 v177, v114, v115
  v_cvt_pk_bf16_f32 v178, v116, v117
  v_cvt_pk_bf16_f32 v179, v118, v119
  v_cvt_pk_bf16_f32 v180, v120, v121
  v_cvt_pk_bf16_f32 v181, v122, v123
  v_cvt_pk_bf16_f32 v182, v124, v125
  v_cvt_pk_bf16_f32 v183, v126, v127
  v_cvt_pk_bf16_f32 v184, v128, v129
  v_cvt_pk_bf16_f32 v185, v130, v131
  v_cvt_pk_bf16_f32 v186, v132, v133
  v_cvt_pk_bf16_f32 v187, v134, v135
  v_cvt_pk_bf16_f32 v188, v136, v137
  v_cvt_pk_bf16_f32 v189, v138, v139
  v_cvt_pk_bf16_f32 v190, v140, v141
  v_cvt_pk_bf16_f32 v191, v142, v143
  v_cvt_pk_bf16_f32 v192, v144, v145
  v_cvt_pk_bf16_f32 v193, v146, v147
  v_cvt_pk_bf16_f32 v194, v148, v149
  v_cvt_pk_bf16_f32 v195, v150, v151
  v_cvt_pk_bf16_f32 v196, v152, v153
  v_cvt_pk_bf16_f32 v197, v154, v155
  v_cvt_pk_bf16_f32 v198, v156, v157
  v_cvt_pk_bf16_f32 v199, v158, v159
  ds_write_b128 v8, v[176:179]
  ds_write_b128 v9, v[180:183]
  ds_write_b128 v10, v[184:187]
  ds_write_b128 v11, v[188:191]
  ds_write_b128 v12, v[192:195]
  ds_write_b128 v13, v[196:199]
  s_branch FOLD_DONE_T
FOLD_TAIL:
  v_add_f32 v14, v112, v116
  v_add_f32 v15, v113, v117
  v_add_f32 v16, v114, v118
  v_add_f32 v17, v115, v119
  v_add_f32 v14, v14, v120
  v_add_f32 v15, v15, v121
  v_add_f32 v16, v16, v122
  v_add_f32 v17, v17, v123
  v_add_f32 v14, v14, v124
  v_add_f32 v15, v15, v125
  v_add_f32 v16, v16, v126
  v_add_f32 v17, v17, v127
  v_add_f32 v14, v14, v128
  v_add_f32 v15, v15, v129
  v_add_f32 v16, v16, v130
  v_add_f32 v17, v17, v131
  v_add_f32 v14, v14, v132
  v_add_f32 v15, v15, v133
  v_add_f32 v16, v16, v134
  v_add_f32 v17, v17, v135
  v_add_f32 v14, v14, v136
  v_add_f32 v15, v15, v137
  v_add_f32 v16, v16, v138
  v_add_f32 v17, v17, v139
  v_add_f32 v14, v14, v140
  v_add_f32 v15, v15, v141
  v_add_f32 v16, v16, v142
  v_add_f32 v17, v17, v143
  v_add_f32 v14, v14, v144
  v_add_f32 v15, v15, v145
  v_add_f32 v16, v16, v146
  v_add_f32 v17, v17, v147
  v_add_f32 v14, v14, v148
  v_add_f32 v15, v15, v149
  v_add_f32 v16, v16, v150
  v_add_f32 v17, v17, v151
  v_add_f32 v14, v14, v152
  v_add_f32 v15, v15, v153
  v_add_f32 v16, v16, v154
  v_add_f32 v17, v17, v155
  v_add_f32 v14, v14, v156
  v_add_f32 v15, v15, v157
  v_add_f32 v16, v16, v158
  v_add_f32 v17, v17, v159
  v_add_f32 v14, v14, v15
  v_add_f32 v16, v16, v17
  s_cmp_eq_u32 s75, 0
  v_add_f32 v14, v14, v16
  s_cselect_b64 s[48:49], -1, 0
  v_mov_b32 v15, v14
  v_cndmask_b32_e64 v8, v24, v23, s[48:49]
  v_add_u32 v8, s62, v8
  v_permlane32_swap_b32 v14, v15
  v_add_f32 v14, v14, v15
  v_add_u32 v9, s64, v8
  v_mul_f32 v14, s67, v14
  v_add_u32 v10, s63, v8
  v_add_u32 v11, s63, v9
  v_fma_f32 v112, v112, s66, v14
  v_fma_f32 v113, v113, s66, v14
  v_fma_f32 v114, v114, s66, v14
  v_fma_f32 v115, v115, s66, v14
  v_fma_f32 v116, v116, s66, v14
  v_fma_f32 v117, v117, s66, v14
  v_fma_f32 v118, v118, s66, v14
  v_fma_f32 v119, v119, s66, v14
  v_fma_f32 v120, v120, s66, v14
  v_fma_f32 v121, v121, s66, v14
  v_fma_f32 v122, v122, s66, v14
  v_fma_f32 v123, v123, s66, v14
  v_fma_f32 v124, v124, s66, v14
  v_fma_f32 v125, v125, s66, v14
  v_fma_f32 v126, v126, s66, v14
  v_fma_f32 v127, v127, s66, v14
  v_fma_f32 v128, v128, s66, v14
  v_fma_f32 v129, v129, s66, v14
  v_fma_f32 v130, v130, s66, v14
  v_fma_f32 v131, v131, s66, v14
  v_fma_f32 v132, v132, s66, v14
  v_fma_f32 v133, v133, s66, v14
  v_fma_f32 v134, v134, s66, v14
  v_fma_f32 v135, v135, s66, v14
  v_fma_f32 v136, v136, s66, v14
  v_fma_f32 v137, v137, s66, v14
  v_fma_f32 v138, v138, s66, v14
  v_fma_f32 v139, v139, s66, v14
  v_fma_f32 v140, v140, s66, v14
  v_fma_f32 v141, v141, s66, v14
  v_fma_f32 v142, v142, s66, v14
  v_fma_f32 v143, v143, s66, v14
  v_fma_f32 v144, v144, s66, v14
  v_fma_f32 v145, v145, s66, v14
  v_fma_f32 v146, v146, s66, v14
  v_fma_f32 v147, v147, s66, v14
  v_fma_f32 v148, v148, s66, v14
  v_fma_f32 v149, v149, s66, v14
  v_fma_f32 v150, v150, s66, v14
  v_fma_f32 v151, v151, s66, v14
  v_fma_f32 v152, v152, s66, v14
  v_fma_f32 v153, v153, s66, v14
  v_fma_f32 v154, v154, s66, v14
  v_fma_f32 v155, v155, s66, v14
  v_fma_f32 v156, v156, s66, v14
  v_fma_f32 v157, v157, s66, v14
  v_fma_f32 v158, v158, s66, v14
  v_fma_f32 v159, v159, s66, v14
  v_add_u32 v12, s63, v10
  v_add_u32 v13, s63, v11
  v_cvt_pk_bf16_f32 v176, v112, v113
  v_cvt_pk_bf16_f32 v177, v114, v115
  v_cvt_pk_bf16_f32 v178, v116, v117
  v_cvt_pk_bf16_f32 v179, v118, v119
  v_cvt_pk_bf16_f32 v180, v120, v121
  v_cvt_pk_bf16_f32 v181, v122, v123
  v_cvt_pk_bf16_f32 v182, v124, v125
  v_cvt_pk_bf16_f32 v183, v126, v127
  v_cvt_pk_bf16_f32 v184, v128, v129
  v_cvt_pk_bf16_f32 v185, v130, v131
  v_cvt_pk_bf16_f32 v186, v132, v133
  v_cvt_pk_bf16_f32 v187, v134, v135
  v_cvt_pk_bf16_f32 v188, v136, v137
  v_cvt_pk_bf16_f32 v189, v138, v139
  v_cvt_pk_bf16_f32 v190, v140, v141
  v_cvt_pk_bf16_f32 v191, v142, v143
  v_cvt_pk_bf16_f32 v192, v144, v145
  v_cvt_pk_bf16_f32 v193, v146, v147
  v_cvt_pk_bf16_f32 v194, v148, v149
  v_cvt_pk_bf16_f32 v195, v150, v151
  v_cvt_pk_bf16_f32 v196, v152, v153
  v_cvt_pk_bf16_f32 v197, v154, v155
  v_cvt_pk_bf16_f32 v198, v156, v157
  v_cvt_pk_bf16_f32 v199, v158, v159
  ds_write_b128 v8, v[176:179]
  ds_write_b128 v9, v[180:183]
  ds_write_b128 v10, v[184:187]
  ds_write_b128 v11, v[188:191]
  ds_write_b128 v12, v[192:195]
  ds_write_b128 v13, v[196:199]
  s_waitcnt lgkmcnt(0)
  s_cmp_eq_u32 s65, 3
  s_cbranch_scc1 S_R0_DONE
  s_branch FOLD_DONE_T
FOLD_DONE_T:
  s_waitcnt vmcnt(0) lgkmcnt(0)
  s_barrier
  s_cmp_ge_u32 s20, 4
  s_cbranch_scc1 S_PRO2
  v_lshlrev_b32 v20, 4, v0
  v_add_u32 v21, 0x9000, v20
  ds_read_b128 v[112:115], v21 offset:0
  ds_read_b128 v[116:119], v21 offset:1024
  ds_read_b128 v[120:123], v21 offset:2048
  ds_read_b128 v[124:127], v21 offset:3072
  ds_read_b128 v[128:131], v21 offset:4096
  ds_read_b128 v[132:135], v21 offset:5120
  ds_read_b128 v[136:139], v21 offset:6144
  ds_read_b128 v[140:143], v21 offset:7168
  ds_read_b128 v[144:147], v21 offset:8192
  ds_read_b128 v[148:151], v21 offset:9216
  ds_read_b128 v[152:155], v21 offset:10240
  ds_read_b128 v[156:159], v21 offset:11264
  ds_read_b128 v[160:163], v21 offset:12288
  ds_read_b128 v[164:167], v21 offset:13312
  ds_read_b128 v[168:171], v21 offset:14336
  ds_read_b128 v[172:175], v21 offset:15360
  ds_read_b128 v[176:179], v21 offset:16384
  ds_read_b128 v[180:183], v21 offset:17408
  ds_read_b128 v[184:187], v21 offset:18432
  ds_read_b128 v[188:191], v21 offset:19456
  ds_read_b128 v[192:195], v21 offset:20480
  ds_read_b128 v[196:199], v21 offset:21504
  ds_read_b128 v[200:203], v21 offset:22528
  ds_read_b128 v[204:207], v21 offset:23552
  ds_read_b128 v[208:211], v21 offset:24576
  ds_read_b128 v[212:215], v21 offset:25600
  ds_read_b128 v[216:219], v21 offset:26624
  ds_read_b128 v[220:223], v21 offset:27648
  ds_read_b128 v[224:227], v21 offset:28672
  ds_read_b128 v[228:231], v21 offset:29696
  ds_read_b128 v[232:235], v21 offset:30720
  ds_read_b128 v[236:239], v21 offset:31744
  ds_read_b128 v[240:243], v21 offset:32768
  ds_read_b128 v[244:247], v21 offset:33792
  ds_read_b128 v[248:251], v21 offset:34816
  ds_read_b128 v[252:255], v21 offset:35840
  v_mov_b32 v8, 0x3f803f80
  v_mov_b32 v9, 0x3f803f80
  v_mov_b32 v10, 0x3f803f80
  v_mov_b32 v11, 0x3f803f80
  v_and_b32 v22, 15, v0
  v_lshrrev_b32 v23, 4, v0
  v_and_b32 v24, 3, v22
  v_lshrrev_b32 v25, 2, v22
  s_mul_i32 s49, s20, 12
  v_add_u32 v26, s49, v25
  v_mul_u32_u24 v27, 0xc0, v26
  v_mul_u32_u24 v28, 0x2400, v24
  v_add_u32 v27, v27, v28
  v_add_u32 v27, 0x12000, v27
  v_xor_b32 v28, v23, v24
  s_mul_i32 s49, s20, 3
  s_add_u32 s50, s49, 0
  s_and_b32 s50, s50, 3
  v_xor_b32 v29, s50, v28
  v_lshl_add_u32 v1, v29, 4, v27
  s_add_u32 s50, s49, 1
  s_and_b32 s50, s50, 3
  v_xor_b32 v29, s50, v28
  v_lshl_add_u32 v2, v29, 4, v27
  s_add_u32 s50, s49, 2
  s_and_b32 s50, s50, 3
  v_xor_b32 v29, s50, v28
  v_lshl_add_u32 v3, v29, 4, v27
  v_add_u32 v29, 49, v23
  v_cndmask_b32_e64 v29, v29, v26, s[30:31]
  v_lshlrev_b32 v29, 2, v29
  v_lshl_add_u32 v29, v24, 8, v29
  v_add_u32 v4, 0x24c00, v29
  s_mov_b64 vcc, 0
  s_setprio 1
T_LOOP:
  ds_read_b128 v[28:31], v1 offset:0
  ds_read_b128 v[32:35], v1 offset:64
  ds_read_b128 v[36:39], v1 offset:128
  ds_read_b128 v[40:43], v2 offset:768
  ds_read_b128 v[44:47], v2 offset:832
  ds_read_b128 v[48:51], v2 offset:896
  s_waitcnt lgkmcnt(5)
  v_mfma_f32_16x16x32_bf16 v[52:55], v[112:115], v[28:31], 0
  v_mfma_f32_16x16x32_bf16 v[56:59], v[124:127], v[28:31], 0
  v_mfma_f32_16x16x32_bf16 v[12:15], v[8:11], v[28:31], 0
  s_waitcnt lgkmcnt(4)
  v_mfma_f32_16x16x32_bf16 v[52:55], v[116:119], v[32:35], v[52:55]
  v_mfma_f32_16x16x32_bf16 v[60:63], v[136:139], v[28:31], 0
  v_mfma_f32_16x16x32_bf16 v[56:59], v[128:131], v[32:35], v[56:59]
  v_mfma_f32_16x16x32_bf16 v[64:67], v[148:151], v[28:31], 0
  v_mfma_f32_16x16x32_bf16 v[12:15], v[8:11], v[32:35], v[12:15]
  s_waitcnt lgkmcnt(3)
  v_mfma_f32_16x16x32_bf16 v[52:55], v[120:123], v[36:39], v[52:55]
  v_mfma_f32_16x16x32_bf16 v[60:63], v[140:143], v[32:35], v[60:63]
  v_mfma_f32_16x16x32_bf16 v[68:71], v[160:163], v[28:31], 0
  s_nop 5
  v_cvt_pk_bf16_f32 v52, v52, v53
  v_mfma_f32_16x16x32_bf16 v[56:59], v[132:135], v[36:39], v[56:59]
  v_cvt_pk_bf16_f32 v53, v54, v55
  v_mfma_f32_16x16x32_bf16 v[64:67], v[152:155], v[32:35], v[64:67]
  v_mfma_f32_16x16x32_bf16 v[72:75], v[172:175], v[28:31], 0
  s_nop 4
  v_cvt_pk_bf16_f32 v54, v56, v57
  v_mfma_f32_16x16x32_bf16 v[16:19], v[28:31], v[28:31], 0
  v_cvt_pk_bf16_f32 v55, v58, v59
  v_mfma_f32_16x16x32_bf16 v[12:15], v[8:11], v[36:39], v[12:15]
  v_mfma_f32_16x16x32_bf16 v[60:63], v[144:147], v[36:39], v[60:63]
  v_mfma_f32_16x16x32_bf16 v[68:71], v[164:167], v[32:35], v[68:71]
  s_nop 5
  v_mul_f32 v5, v12, v12
  v_mfma_f32_16x16x32_bf16 v[64:67], v[156:159], v[36:39], v[64:67]
  v_cvt_pk_bf16_f32 v60, v60, v61
  v_mfma_f32_16x16x32_bf16 v[72:75], v[176:179], v[32:35], v[72:75]
  v_cvt_pk_bf16_f32 v61, v62, v63
  v_mfma_f32_16x16x32_bf16 v[16:19], v[32:35], v[32:35], v[16:19]
  s_nop 3
  v_cvt_pk_bf16_f32 v62, v64, v65
  v_mfma_f32_16x16x32_bf16 v[68:71], v[168:171], v[36:39], v[68:71]
  v_cvt_pk_bf16_f32 v63, v66, v67
  v_mfma_f32_16x16x32_bf16 v[72:75], v[180:183], v[36:39], v[72:75]
  v_mfma_f32_16x16x32_bf16 v[16:19], v[36:39], v[36:39], v[16:19]
  s_nop 4
  v_cvt_pk_bf16_f32 v68, v68, v69
  v_mfma_f32_16x16x32_bf16 v[12:15], v[28:31], v[52:55], 0
  v_cvt_pk_bf16_f32 v69, v70, v71
  v_cvt_pk_bf16_f32 v70, v72, v73
  v_mfma_f32_16x16x32_bf16 v[12:15], v[32:35], v[60:63], v[12:15]
  v_cvt_pk_bf16_f32 v71, v74, v75
  v_cndmask_b32_e64 v21, v16, v17, s[32:33]
  s_waitcnt lgkmcnt(2)
  v_mfma_f32_16x16x32_bf16 v[52:55], v[112:115], v[40:43], 0
  v_cndmask_b32_e64 v21, v21, v18, s[34:35]
  v_cndmask_b32_e64 v21, v21, v19, s[36:37]
  v_mfma_f32_16x16x32_bf16 v[12:15], v[36:39], v[68:71], v[12:15]
  v_fma_f32 v5, v5, s28, v21
  v_mfma_f32_16x16x32_bf16 v[56:59], v[124:127], v[40:43], 0
  v_add_f32 v5, 0x3a7ba882, v5
  v_max_f32 v5, 0x3a7ba882, v5
  s_waitcnt lgkmcnt(1)
  v_mfma_f32_16x16x32_bf16 v[52:55], v[116:119], v[44:47], v[52:55]
  v_rsq_f32 v5, v5
  v_mfma_f32_16x16x32_bf16 v[60:63], v[136:139], v[40:43], 0
  s_nop 0
  v_mul_f32_dpp v12, v5, v12 quad_perm:[0,0,0,0] row_mask:0xf bank_mask:0xf
  v_mul_f32_dpp v13, v5, v13 quad_perm:[1,1,1,1] row_mask:0xf bank_mask:0xf
  v_mul_f32_dpp v14, v5, v14 quad_perm:[2,2,2,2] row_mask:0xf bank_mask:0xf
  v_mul_f32_dpp v15, v5, v15 quad_perm:[3,3,3,3] row_mask:0xf bank_mask:0xf
  v_max3_f32 v6, v12, v13, v14
  v_mul_f32 v7, s27, v5
  v_max_f32 v6, v6, v15
  v_mfma_f32_16x16x32_bf16 v[56:59], v[128:131], v[44:47], v[56:59]
  v_mul_f32 v6, v6, v7
  v_mfma_f32_16x16x32_bf16 v[64:67], v[148:151], v[40:43], 0
  v_fma_f32 v12, v12, v7, -v6
  v_fma_f32 v13, v13, v7, -v6
  v_fma_f32 v14, v14, v7, -v6
  v_fma_f32 v15, v15, v7, -v6
  v_exp_f32 v12, v12
  v_exp_f32 v13, v13
  v_exp_f32 v14, v14
  v_exp_f32 v15, v15
  v_add_f32 v20, v12, v13
  v_add_f32 v6, v14, v15
  v_mul_f32_dpp v12, v5, v12 quad_perm:[0,0,0,0] row_mask:0xf bank_mask:0xf
  v_add_f32 v20, v20, v6
  v_mul_f32_dpp v13, v5, v13 quad_perm:[1,1,1,1] row_mask:0xf bank_mask:0xf
  v_rcp_f32 v20, v20
  v_mul_f32_dpp v14, v5, v14 quad_perm:[2,2,2,2] row_mask:0xf bank_mask:0xf
  v_mul_f32_dpp v15, v5, v15 quad_perm:[3,3,3,3] row_mask:0xf bank_mask:0xf
  v_cndmask_b32_e64 v20, 0, v20, s[30:31]
  s_waitcnt lgkmcnt(0)
  v_mfma_f32_16x16x32_bf16 v[52:55], v[120:123], v[48:51], v[52:55]
  v_mul_f32 v12, v12, v20
  v_mul_f32 v13, v13, v20
  v_mul_f32 v14, v14, v20
  v_mul_f32 v15, v15, v20
  v_cvt_pk_bf16_f32 v24, v12, v13
  v_cvt_pk_bf16_f32 v25, v14, v15
  v_mfma_f32_16x16x32_bf16 v[12:15], v[8:11], v[40:43], 0
  v_mfma_f32_16x16x32_bf16 v[60:63], v[140:143], v[44:47], v[60:63]
  v_cvt_pk_bf16_f32 v52, v52, v53
  v_cvt_pk_bf16_f32 v53, v54, v55
  v_mfma_f32_16x16x32_bf16 v[12:15], v[8:11], v[44:47], v[12:15]
  v_mfma_f32_16x16x32_bf16 v[68:71], v[160:163], v[40:43], 0
  v_mfma_f32_16x16x32_bf16 v[56:59], v[132:135], v[48:51], v[56:59]
  v_mfma_f32_16x16x32_bf16 v[64:67], v[152:155], v[44:47], v[64:67]
  v_mfma_f32_16x16x32_bf16 v[72:75], v[172:175], v[40:43], 0
  s_nop 5
  v_cvt_pk_bf16_f32 v54, v56, v57
  v_mfma_f32_16x16x32_bf16 v[16:19], v[40:43], v[40:43], 0
  v_cvt_pk_bf16_f32 v55, v58, v59
  v_mfma_f32_16x16x32_bf16 v[12:15], v[8:11], v[48:51], v[12:15]
  v_mfma_f32_16x16x32_bf16 v[60:63], v[144:147], v[48:51], v[60:63]
  v_mfma_f32_16x16x32_bf16 v[68:71], v[164:167], v[44:47], v[68:71]
  s_nop 5
  v_mul_f32 v5, v12, v12
  v_mfma_f32_16x16x32_bf16 v[64:67], v[156:159], v[48:51], v[64:67]
  v_cvt_pk_bf16_f32 v60, v60, v61
  v_mfma_f32_16x16x32_bf16 v[72:75], v[176:179], v[44:47], v[72:75]
  v_cvt_pk_bf16_f32 v61, v62, v63
  v_mfma_f32_16x16x32_bf16 v[76:79], v[28:31], v[184:187], 0
  s_nop 3
  v_cvt_pk_bf16_f32 v62, v64, v65
  v_mfma_f32_16x16x32_bf16 v[80:83], v[28:31], v[196:199], 0
  v_cvt_pk_bf16_f32 v63, v66, v67
  v_mfma_f32_16x16x32_bf16 v[16:19], v[44:47], v[44:47], v[16:19]
  v_mfma_f32_16x16x32_bf16 v[68:71], v[168:171], v[48:51], v[68:71]
  v_mfma_f32_16x16x32_bf16 v[72:75], v[180:183], v[48:51], v[72:75]
  v_mfma_f32_16x16x32_bf16 v[76:79], v[32:35], v[188:191], v[76:79]
  s_nop 5
  v_cvt_pk_bf16_f32 v68, v68, v69
  s_cbranch_vccnz T_NOB4
  s_barrier
  s_mov_b64 vcc, -1
T_NOB4:
  v_mfma_f32_16x16x32_bf16 v[84:87], v[28:31], v[208:211], 0
  v_cvt_pk_bf16_f32 v69, v70, v71
  v_cvt_pk_bf16_f32 v70, v72, v73
  v_mfma_f32_16x16x32_bf16 v[80:83], v[32:35], v[200:203], v[80:83]
  v_cvt_pk_bf16_f32 v71, v74, v75
  v_mfma_f32_16x16x32_bf16 v[88:91], v[28:31], v[220:223], 0
  v_mfma_f32_16x16x32_bf16 v[16:19], v[48:51], v[48:51], v[16:19]
  v_mfma_f32_16x16x32_bf16 v[76:79], v[36:39], v[192:195], v[76:79]
  v_mfma_f32_16x16x32_bf16 v[84:87], v[32:35], v[212:215], v[84:87]
  s_nop 5
  v_cndmask_b32_e64 v21, v16, v17, s[32:33]
  v_mfma_f32_16x16x32_bf16 v[92:95], v[28:31], v[232:235], 0
  v_cndmask_b32_e64 v21, v21, v18, s[34:35]
  v_cvt_pk_bf16_f32 v100, v76, v77
  v_mfma_f32_16x16x32_bf16 v[80:83], v[36:39], v[204:207], v[80:83]
  v_cvt_pk_bf16_f32 v101, v78, v79
  v_lshlrev_b32 v76, 16, v28
  v_mfma_f32_16x16x32_bf16 v[88:91], v[32:35], v[224:227], v[88:91]
  v_and_b32 v77, 0xffff0000, v28
  v_lshlrev_b32 v78, 16, v29
  v_mfma_f32_16x16x32_bf16 v[96:99], v[28:31], v[244:247], 0
  v_and_b32 v79, 0xffff0000, v29
  v_cndmask_b32_e64 v21, v21, v19, s[36:37]
  v_mfma_f32_16x16x32_bf16 v[12:15], v[40:43], v[52:55], 0
  v_cvt_pk_bf16_f32 v102, v80, v81
  v_cvt_pk_bf16_f32 v103, v82, v83
  v_mfma_f32_16x16x32_bf16 v[84:87], v[36:39], v[216:219], v[84:87]
  v_lshlrev_b32 v80, 16, v30
  v_and_b32 v81, 0xffff0000, v30
  v_mfma_f32_16x16x32_bf16 v[92:95], v[32:35], v[236:239], v[92:95]
  v_lshlrev_b32 v82, 16, v31
  v_and_b32 v83, 0xffff0000, v31
  v_mfma_f32_16x16x32_bf16 v[88:91], v[36:39], v[228:231], v[88:91]
  ds_read_b128 v[28:31], v3 offset:1536
  v_fma_f32 v5, v5, s28, v21
  v_mfma_f32_16x16x32_bf16 v[96:99], v[32:35], v[248:251], v[96:99]
  v_cvt_pk_bf16_f32 v104, v84, v85
  v_cvt_pk_bf16_f32 v105, v86, v87
  v_mfma_f32_16x16x32_bf16 v[12:15], v[44:47], v[60:63], v[12:15]
  v_lshlrev_b32 v84, 16, v32
  v_and_b32 v85, 0xffff0000, v32
  v_mfma_f32_16x16x32_bf16 v[92:95], v[36:39], v[240:243], v[92:95]
  v_lshlrev_b32 v86, 16, v33
  v_and_b32 v87, 0xffff0000, v33
  v_mfma_f32_16x16x32_bf16 v[96:99], v[36:39], v[252:255], v[96:99]
  v_cvt_pk_bf16_f32 v106, v88, v89
  v_cvt_pk_bf16_f32 v107, v90, v91
  v_mfma_f32_16x16x32_bf16 v[12:15], v[48:51], v[68:71], v[12:15]
  v_lshlrev_b32 v88, 16, v34
  v_and_b32 v89, 0xffff0000, v34
  v_mfma_f32_16x16x16_bf16 v[76:79], v[100:101], v[24:25], v[76:79]
  v_lshlrev_b32 v90, 16, v35
  v_and_b32 v91, 0xffff0000, v35
  v_mfma_f32_16x16x16_bf16 v[80:83], v[102:103], v[24:25], v[80:83]
  v_add_f32 v5, 0x3a7ba882, v5
  ds_read_b128 v[32:35], v3 offset:1600
  v_max_f32 v5, 0x3a7ba882, v5
  v_mfma_f32_16x16x16_bf16 v[84:87], v[104:105], v[24:25], v[84:87]
  v_cvt_pk_bf16_f32 v108, v92, v93
  v_mfma_f32_16x16x16_bf16 v[88:91], v[106:107], v[24:25], v[88:91]
  v_cvt_pk_bf16_f32 v109, v94, v95
  v_lshlrev_b32 v92, 16, v36
  v_and_b32 v93, 0xffff0000, v36
  v_lshlrev_b32 v94, 16, v37
  v_and_b32 v95, 0xffff0000, v37
  v_rsq_f32 v5, v5
  v_cvt_pk_bf16_f32 v110, v96, v97
  v_cvt_pk_bf16_f32 v111, v98, v99
  v_lshlrev_b32 v96, 16, v38
  v_and_b32 v97, 0xffff0000, v38
  v_lshlrev_b32 v98, 16, v39
  v_and_b32 v99, 0xffff0000, v39
  ds_read_b128 v[36:39], v3 offset:1664
  v_mfma_f32_16x16x16_bf16 v[92:95], v[108:109], v[24:25], v[92:95]
  v_mul_f32_dpp v12, v5, v12 quad_perm:[0,0,0,0] row_mask:0xf bank_mask:0xf
  v_mfma_f32_16x16x16_bf16 v[96:99], v[110:111], v[24:25], v[96:99]
  v_mul_f32_dpp v13, v5, v13 quad_perm:[1,1,1,1] row_mask:0xf bank_mask:0xf
  v_mul_f32_dpp v14, v5, v14 quad_perm:[2,2,2,2] row_mask:0xf bank_mask:0xf
  v_mul_f32_dpp v15, v5, v15 quad_perm:[3,3,3,3] row_mask:0xf bank_mask:0xf
  v_max3_f32 v6, v12, v13, v14
  v_mul_f32 v7, s27, v5
  v_max_f32 v6, v6, v15
  v_cvt_pk_bf16_f32 v76, v76, v77
  v_cvt_pk_bf16_f32 v77, v78, v79
  v_cvt_pk_bf16_f32 v78, v80, v81
  v_cvt_pk_bf16_f32 v79, v82, v83
  v_mul_f32 v6, v6, v7
  v_cvt_pk_bf16_f32 v84, v84, v85
  v_fma_f32 v12, v12, v7, -v6
  v_fma_f32 v13, v13, v7, -v6
  v_fma_f32 v14, v14, v7, -v6
  v_fma_f32 v15, v15, v7, -v6
  v_mfma_f32_16x16x32_bf16 v[104:107], v[76:79], v[76:79], 0
  v_cvt_pk_bf16_f32 v85, v86, v87
  v_exp_f32 v12, v12
  v_exp_f32 v13, v13
  v_exp_f32 v14, v14
  v_exp_f32 v15, v15
  v_cvt_pk_bf16_f32 v86, v88, v89
  v_cvt_pk_bf16_f32 v87, v90, v91
  v_mfma_f32_16x16x32_bf16 v[100:103], v[8:11], v[76:79], 0
  v_add_f32 v20, v12, v13
  v_mfma_f32_16x16x32_bf16 v[104:107], v[84:87], v[84:87], v[104:107]
  v_add_f32 v6, v14, v15
  v_cvt_pk_bf16_f32 v92, v92, v93
  v_cvt_pk_bf16_f32 v93, v94, v95
  v_cvt_pk_bf16_f32 v94, v96, v97
  v_cvt_pk_bf16_f32 v95, v98, v99
  ds_write_b128 v1, v[76:79] offset:0
  v_add_f32 v20, v20, v6
  v_mfma_f32_16x16x32_bf16 v[100:103], v[8:11], v[84:87], v[100:103]
  v_rcp_f32 v20, v20
  v_mfma_f32_16x16x32_bf16 v[104:107], v[92:95], v[92:95], v[104:107]
  ds_write_b128 v1, v[84:87] offset:64
  v_mfma_f32_16x16x32_bf16 v[76:79], v[40:43], v[184:187], 0
  v_mul_f32_dpp v12, v5, v12 quad_perm:[0,0,0,0] row_mask:0xf bank_mask:0xf
  v_mfma_f32_16x16x32_bf16 v[80:83], v[40:43], v[196:199], 0
  v_mul_f32_dpp v13, v5, v13 quad_perm:[1,1,1,1] row_mask:0xf bank_mask:0xf
  v_mul_f32_dpp v14, v5, v14 quad_perm:[2,2,2,2] row_mask:0xf bank_mask:0xf
  v_mul_f32_dpp v15, v5, v15 quad_perm:[3,3,3,3] row_mask:0xf bank_mask:0xf
  v_cndmask_b32_e64 v20, 0, v20, s[30:31]
  v_mfma_f32_16x16x32_bf16 v[100:103], v[8:11], v[92:95], v[100:103]
  v_mul_f32 v12, v12, v20
  s_waitcnt lgkmcnt(4)
  v_mfma_f32_16x16x32_bf16 v[52:55], v[112:115], v[28:31], 0
  v_mul_f32 v13, v13, v20
  v_mul_f32 v14, v14, v20
  v_mfma_f32_16x16x32_bf16 v[56:59], v[124:127], v[28:31], 0
  v_mul_f32 v15, v15, v20
  ds_write_b128 v1, v[92:95] offset:128
  v_mfma_f32_16x16x32_bf16 v[76:79], v[44:47], v[188:191], v[76:79]
  v_cvt_pk_bf16_f32 v24, v12, v13
  v_mfma_f32_16x16x32_bf16 v[84:87], v[40:43], v[208:211], 0
  v_cvt_pk_bf16_f32 v25, v14, v15
  v_cndmask_b32_e64 v109, v104, v105, s[32:33]
  v_mfma_f32_16x16x32_bf16 v[80:83], v[44:47], v[200:203], v[80:83]
  v_cndmask_b32_e64 v109, v109, v106, s[34:35]
  v_mul_f32 v108, v100, v100
  v_mfma_f32_16x16x32_bf16 v[88:91], v[40:43], v[220:223], 0
  v_cndmask_b32_e64 v109, v109, v107, s[36:37]
  v_add_u32 v1, s26, v1
  v_mfma_f32_16x16x32_bf16 v[12:15], v[8:11], v[28:31], 0
  v_fma_f32 v108, v108, s28, v109
  s_waitcnt lgkmcnt(4)
  v_mfma_f32_16x16x32_bf16 v[52:55], v[116:119], v[32:35], v[52:55]
  v_add_f32 v108, 0x3a7ba882, v108
  v_max_f32 v108, 0x3a7ba882, v108
  v_mfma_f32_16x16x32_bf16 v[60:63], v[136:139], v[28:31], 0
  v_rsq_f32 v108, v108
  v_mfma_f32_16x16x32_bf16 v[56:59], v[128:131], v[32:35], v[56:59]
  ds_write_b32 v4, v108 offset:0
  v_mfma_f32_16x16x32_bf16 v[64:67], v[148:151], v[28:31], 0
  v_mfma_f32_16x16x32_bf16 v[76:79], v[48:51], v[192:195], v[76:79]
  v_mfma_f32_16x16x32_bf16 v[84:87], v[44:47], v[212:215], v[84:87]
  v_mfma_f32_16x16x32_bf16 v[92:95], v[40:43], v[232:235], 0
  s_nop 5
  v_cvt_pk_bf16_f32 v100, v76, v77
  v_mfma_f32_16x16x32_bf16 v[80:83], v[48:51], v[204:207], v[80:83]
  v_cvt_pk_bf16_f32 v101, v78, v79
  v_lshlrev_b32 v76, 16, v40
  v_mfma_f32_16x16x32_bf16 v[88:91], v[44:47], v[224:227], v[88:91]
  v_and_b32 v77, 0xffff0000, v40
  v_lshlrev_b32 v78, 16, v41
  v_mfma_f32_16x16x32_bf16 v[96:99], v[40:43], v[244:247], 0
  v_and_b32 v79, 0xffff0000, v41
  s_nop 0
  v_cvt_pk_bf16_f32 v102, v80, v81
  v_mfma_f32_16x16x32_bf16 v[12:15], v[8:11], v[32:35], v[12:15]
  v_cvt_pk_bf16_f32 v103, v82, v83
  v_lshlrev_b32 v80, 16, v42
  s_waitcnt lgkmcnt(4)
  v_mfma_f32_16x16x32_bf16 v[52:55], v[120:123], v[36:39], v[52:55]
  v_and_b32 v81, 0xffff0000, v42
  v_lshlrev_b32 v82, 16, v43
  v_mfma_f32_16x16x32_bf16 v[60:63], v[140:143], v[32:35], v[60:63]
  v_and_b32 v83, 0xffff0000, v43
  v_mfma_f32_16x16x32_bf16 v[68:71], v[160:163], v[28:31], 0
  s_nop 2
  v_cvt_pk_bf16_f32 v52, v52, v53
  v_mfma_f32_16x16x32_bf16 v[56:59], v[132:135], v[36:39], v[56:59]
  v_cvt_pk_bf16_f32 v53, v54, v55
  v_mfma_f32_16x16x32_bf16 v[64:67], v[152:155], v[32:35], v[64:67]
  v_mfma_f32_16x16x32_bf16 v[72:75], v[172:175], v[28:31], 0
  s_nop 4
  v_cvt_pk_bf16_f32 v54, v56, v57
  v_mfma_f32_16x16x32_bf16 v[84:87], v[48:51], v[216:219], v[84:87]
  v_cvt_pk_bf16_f32 v55, v58, v59
  v_mfma_f32_16x16x32_bf16 v[92:95], v[44:47], v[236:239], v[92:95]
  v_mfma_f32_16x16x32_bf16 v[88:91], v[48:51], v[228:231], v[88:91]
  s_nop 4
  v_cvt_pk_bf16_f32 v104, v84, v85
  v_mfma_f32_16x16x32_bf16 v[96:99], v[44:47], v[248:251], v[96:99]
  v_cvt_pk_bf16_f32 v105, v86, v87
  v_lshlrev_b32 v84, 16, v44
  v_mfma_f32_16x16x32_bf16 v[16:19], v[28:31], v[28:31], 0
  v_and_b32 v85, 0xffff0000, v44
  v_lshlrev_b32 v86, 16, v45
  v_mfma_f32_16x16x32_bf16 v[12:15], v[8:11], v[36:39], v[12:15]
  v_and_b32 v87, 0xffff0000, v45
  v_cvt_pk_bf16_f32 v106, v88, v89
  v_mfma_f32_16x16x32_bf16 v[60:63], v[144:147], v[36:39], v[60:63]
  v_cvt_pk_bf16_f32 v107, v90, v91
  v_lshlrev_b32 v88, 16, v46
  v_mfma_f32_16x16x32_bf16 v[68:71], v[164:167], v[32:35], v[68:71]
  v_and_b32 v89, 0xffff0000, v46
  v_lshlrev_b32 v90, 16, v47
  v_mfma_f32_16x16x32_bf16 v[64:67], v[156:159], v[36:39], v[64:67]
  v_and_b32 v91, 0xffff0000, v47
  v_mul_f32 v5, v12, v12
  v_mfma_f32_16x16x32_bf16 v[72:75], v[176:179], v[32:35], v[72:75]
  v_cvt_pk_bf16_f32 v60, v60, v61
  v_cvt_pk_bf16_f32 v61, v62, v63
  v_mfma_f32_16x16x32_bf16 v[92:95], v[48:51], v[240:243], v[92:95]
  s_nop 1
  v_cvt_pk_bf16_f32 v62, v64, v65
  v_mfma_f32_16x16x32_bf16 v[96:99], v[48:51], v[252:255], v[96:99]
  v_cvt_pk_bf16_f32 v63, v66, v67
  v_mfma_f32_16x16x32_bf16 v[16:19], v[32:35], v[32:35], v[16:19]
  s_nop 1
  v_cvt_pk_bf16_f32 v108, v92, v93
  v_mfma_f32_16x16x32_bf16 v[68:71], v[168:171], v[36:39], v[68:71]
  v_cvt_pk_bf16_f32 v109, v94, v95
  v_lshlrev_b32 v92, 16, v48
  v_mfma_f32_16x16x32_bf16 v[72:75], v[180:183], v[36:39], v[72:75]
  v_and_b32 v93, 0xffff0000, v48
  v_lshlrev_b32 v94, 16, v49
  v_mfma_f32_16x16x32_bf16 v[16:19], v[36:39], v[36:39], v[16:19]
  v_and_b32 v95, 0xffff0000, v49
  v_cvt_pk_bf16_f32 v110, v96, v97
  v_mfma_f32_16x16x16_bf16 v[76:79], v[100:101], v[24:25], v[76:79]
  v_cvt_pk_bf16_f32 v111, v98, v99
  v_lshlrev_b32 v96, 16, v50
  v_mfma_f32_16x16x16_bf16 v[80:83], v[102:103], v[24:25], v[80:83]
  v_and_b32 v97, 0xffff0000, v50
  v_lshlrev_b32 v98, 16, v51
  v_mfma_f32_16x16x32_bf16 v[12:15], v[28:31], v[52:55], 0
  v_and_b32 v99, 0xffff0000, v51
  v_cvt_pk_bf16_f32 v68, v68, v69
  v_mfma_f32_16x16x16_bf16 v[84:87], v[104:105], v[24:25], v[84:87]
  v_cvt_pk_bf16_f32 v69, v70, v71
  v_cvt_pk_bf16_f32 v70, v72, v73
  v_mfma_f32_16x16x16_bf16 v[88:91], v[106:107], v[24:25], v[88:91]
  v_cvt_pk_bf16_f32 v71, v74, v75
  v_cndmask_b32_e64 v21, v16, v17, s[32:33]
  v_mfma_f32_16x16x32_bf16 v[12:15], v[32:35], v[60:63], v[12:15]
  v_cndmask_b32_e64 v21, v21, v18, s[34:35]
  v_cvt_pk_bf16_f32 v76, v76, v77
  v_mfma_f32_16x16x16_bf16 v[92:95], v[108:109], v[24:25], v[92:95]
  v_cvt_pk_bf16_f32 v77, v78, v79
  v_cvt_pk_bf16_f32 v78, v80, v81
  v_mfma_f32_16x16x16_bf16 v[96:99], v[110:111], v[24:25], v[96:99]
  v_cvt_pk_bf16_f32 v79, v82, v83
  v_cndmask_b32_e64 v21, v21, v19, s[36:37]
  v_mfma_f32_16x16x32_bf16 v[12:15], v[36:39], v[68:71], v[12:15]
  v_fma_f32 v5, v5, s28, v21
  v_cvt_pk_bf16_f32 v84, v84, v85
  v_mfma_f32_16x16x32_bf16 v[104:107], v[76:79], v[76:79], 0
  v_add_f32 v5, 0x3a7ba882, v5
  v_cvt_pk_bf16_f32 v85, v86, v87
  v_cvt_pk_bf16_f32 v86, v88, v89
  v_cvt_pk_bf16_f32 v87, v90, v91
  v_max_f32 v5, 0x3a7ba882, v5
  v_mfma_f32_16x16x32_bf16 v[100:103], v[8:11], v[76:79], 0
  v_rsq_f32 v5, v5
  v_mfma_f32_16x16x32_bf16 v[104:107], v[84:87], v[84:87], v[104:107]
  v_cvt_pk_bf16_f32 v92, v92, v93
  v_cvt_pk_bf16_f32 v93, v94, v95
  v_cvt_pk_bf16_f32 v94, v96, v97
  v_cvt_pk_bf16_f32 v95, v98, v99
  ds_write_b128 v2, v[76:79] offset:768
  v_mfma_f32_16x16x32_bf16 v[100:103], v[8:11], v[84:87], v[100:103]
  v_mul_f32_dpp v12, v5, v12 quad_perm:[0,0,0,0] row_mask:0xf bank_mask:0xf
  v_mul_f32_dpp v13, v5, v13 quad_perm:[1,1,1,1] row_mask:0xf bank_mask:0xf
  v_mul_f32_dpp v14, v5, v14 quad_perm:[2,2,2,2] row_mask:0xf bank_mask:0xf
  v_mfma_f32_16x16x32_bf16 v[104:107], v[92:95], v[92:95], v[104:107]
  v_mul_f32_dpp v15, v5, v15 quad_perm:[3,3,3,3] row_mask:0xf bank_mask:0xf
  v_mfma_f32_16x16x32_bf16 v[76:79], v[28:31], v[184:187], 0
  v_max3_f32 v6, v12, v13, v14
  ds_write_b128 v2, v[84:87] offset:832
  v_mfma_f32_16x16x32_bf16 v[80:83], v[28:31], v[196:199], 0
  v_mul_f32 v7, s27, v5
  v_max_f32 v6, v6, v15
  v_mfma_f32_16x16x32_bf16 v[100:103], v[8:11], v[92:95], v[100:103]
  v_mul_f32 v6, v6, v7
  v_mfma_f32_16x16x32_bf16 v[76:79], v[32:35], v[188:191], v[76:79]
  ds_write_b128 v2, v[92:95] offset:896
  v_mfma_f32_16x16x32_bf16 v[84:87], v[28:31], v[208:211], 0
  v_fma_f32 v12, v12, v7, -v6
  v_fma_f32 v13, v13, v7, -v6
  v_mfma_f32_16x16x32_bf16 v[80:83], v[32:35], v[200:203], v[80:83]
  v_fma_f32 v14, v14, v7, -v6
  v_fma_f32 v15, v15, v7, -v6
  v_mfma_f32_16x16x32_bf16 v[88:91], v[28:31], v[220:223], 0
  v_exp_f32 v12, v12
  v_exp_f32 v13, v13
  v_exp_f32 v14, v14
  v_exp_f32 v15, v15
  v_mfma_f32_16x16x32_bf16 v[76:79], v[36:39], v[192:195], v[76:79]
  v_add_f32 v20, v12, v13
  v_mfma_f32_16x16x32_bf16 v[84:87], v[32:35], v[212:215], v[84:87]
  v_add_f32 v6, v14, v15
  v_cndmask_b32_e64 v109, v104, v105, s[32:33]
  v_mfma_f32_16x16x32_bf16 v[92:95], v[28:31], v[232:235], 0
  v_add_f32 v20, v20, v6
  v_cndmask_b32_e64 v109, v109, v106, s[34:35]
  v_mfma_f32_16x16x32_bf16 v[80:83], v[36:39], v[204:207], v[80:83]
  v_rcp_f32 v20, v20
  v_mfma_f32_16x16x32_bf16 v[88:91], v[32:35], v[224:227], v[88:91]
  v_mul_f32 v108, v100, v100
  v_cndmask_b32_e64 v109, v109, v107, s[36:37]
  v_mfma_f32_16x16x32_bf16 v[96:99], v[28:31], v[244:247], 0
  v_fma_f32 v108, v108, s28, v109
  v_mul_f32_dpp v12, v5, v12 quad_perm:[0,0,0,0] row_mask:0xf bank_mask:0xf
  v_mfma_f32_16x16x32_bf16 v[84:87], v[36:39], v[216:219], v[84:87]
  v_mul_f32_dpp v13, v5, v13 quad_perm:[1,1,1,1] row_mask:0xf bank_mask:0xf
  v_mul_f32_dpp v14, v5, v14 quad_perm:[2,2,2,2] row_mask:0xf bank_mask:0xf
  v_mfma_f32_16x16x32_bf16 v[92:95], v[32:35], v[236:239], v[92:95]
  v_mul_f32_dpp v15, v5, v15 quad_perm:[3,3,3,3] row_mask:0xf bank_mask:0xf
  v_cndmask_b32_e64 v20, 0, v20, s[30:31]
  v_mfma_f32_16x16x32_bf16 v[88:91], v[36:39], v[228:231], v[88:91]
  v_add_f32 v108, 0x3a7ba882, v108
  v_mul_f32 v12, v12, v20
  v_mfma_f32_16x16x32_bf16 v[96:99], v[32:35], v[248:251], v[96:99]
  v_mul_f32 v13, v13, v20
  v_mul_f32 v14, v14, v20
  v_mfma_f32_16x16x32_bf16 v[92:95], v[36:39], v[240:243], v[92:95]
  v_mul_f32 v15, v15, v20
  v_max_f32 v108, 0x3a7ba882, v108
  v_mfma_f32_16x16x32_bf16 v[96:99], v[36:39], v[252:255], v[96:99]
  v_cvt_pk_bf16_f32 v100, v76, v77
  v_cvt_pk_bf16_f32 v101, v78, v79
  v_cvt_pk_bf16_f32 v24, v12, v13
  v_cvt_pk_bf16_f32 v25, v14, v15
  v_lshlrev_b32 v76, 16, v28
  v_and_b32 v77, 0xffff0000, v28
  v_lshlrev_b32 v78, 16, v29
  v_and_b32 v79, 0xffff0000, v29
  v_cvt_pk_bf16_f32 v102, v80, v81
  v_cvt_pk_bf16_f32 v103, v82, v83
  v_lshlrev_b32 v80, 16, v30
  v_and_b32 v81, 0xffff0000, v30
  v_lshlrev_b32 v82, 16, v31
  v_and_b32 v83, 0xffff0000, v31
  v_rsq_f32 v108, v108
  v_mfma_f32_16x16x16_bf16 v[76:79], v[100:101], v[24:25], v[76:79]
  v_cvt_pk_bf16_f32 v104, v84, v85
  v_mfma_f32_16x16x16_bf16 v[80:83], v[102:103], v[24:25], v[80:83]
  v_cvt_pk_bf16_f32 v105, v86, v87
  v_lshlrev_b32 v84, 16, v32
  v_and_b32 v85, 0xffff0000, v32
  v_lshlrev_b32 v86, 16, v33
  v_and_b32 v87, 0xffff0000, v33
  v_cvt_pk_bf16_f32 v106, v88, v89
  v_cvt_pk_bf16_f32 v107, v90, v91
  v_lshlrev_b32 v88, 16, v34
  v_and_b32 v89, 0xffff0000, v34
  v_lshlrev_b32 v90, 16, v35
  v_and_b32 v91, 0xffff0000, v35
  ds_write_b32 v4, v108 offset:16
  v_mfma_f32_16x16x16_bf16 v[84:87], v[104:105], v[24:25], v[84:87]
  v_cvt_pk_bf16_f32 v108, v92, v93
  v_mfma_f32_16x16x16_bf16 v[88:91], v[106:107], v[24:25], v[88:91]
  v_cvt_pk_bf16_f32 v109, v94, v95
  v_lshlrev_b32 v92, 16, v36
  v_and_b32 v93, 0xffff0000, v36
  v_lshlrev_b32 v94, 16, v37
  v_and_b32 v95, 0xffff0000, v37
  v_cvt_pk_bf16_f32 v110, v96, v97
  v_cvt_pk_bf16_f32 v111, v98, v99
  v_lshlrev_b32 v96, 16, v38
  v_and_b32 v97, 0xffff0000, v38
  v_lshlrev_b32 v98, 16, v39
  v_and_b32 v99, 0xffff0000, v39
  v_mfma_f32_16x16x16_bf16 v[92:95], v[108:109], v[24:25], v[92:95]
  v_cvt_pk_bf16_f32 v76, v76, v77
  v_mfma_f32_16x16x16_bf16 v[96:99], v[110:111], v[24:25], v[96:99]
  v_cvt_pk_bf16_f32 v77, v78, v79
  v_cvt_pk_bf16_f32 v78, v80, v81
  v_cvt_pk_bf16_f32 v79, v82, v83
  v_cvt_pk_bf16_f32 v84, v84, v85
  v_cvt_pk_bf16_f32 v85, v86, v87
  v_mfma_f32_16x16x32_bf16 v[104:107], v[76:79], v[76:79], 0
  v_cvt_pk_bf16_f32 v86, v88, v89
  v_cvt_pk_bf16_f32 v87, v90, v91
  v_mfma_f32_16x16x32_bf16 v[100:103], v[8:11], v[76:79], 0
  v_cvt_pk_bf16_f32 v92, v92, v93
  v_mfma_f32_16x16x32_bf16 v[104:107], v[84:87], v[84:87], v[104:107]
  v_cvt_pk_bf16_f32 v93, v94, v95
  v_cvt_pk_bf16_f32 v94, v96, v97
  v_cvt_pk_bf16_f32 v95, v98, v99
  v_mfma_f32_16x16x32_bf16 v[100:103], v[8:11], v[84:87], v[100:103]
  ds_write_b128 v3, v[76:79] offset:1536
  v_mfma_f32_16x16x32_bf16 v[104:107], v[92:95], v[92:95], v[104:107]
  ds_write_b128 v3, v[84:87] offset:1600
  v_mfma_f32_16x16x32_bf16 v[100:103], v[8:11], v[92:95], v[100:103]
  ds_write_b128 v3, v[92:95] offset:1664
  v_add_u32 v2, s26, v2
  v_add_u32 v3, s26, v3
  s_sub_u32 s26, 0, s26
  s_add_u32 s25, s25, 1
  s_nop 0
  v_cndmask_b32_e64 v109, v104, v105, s[32:33]
  v_cndmask_b32_e64 v109, v109, v106, s[34:35]
  v_cndmask_b32_e64 v109, v109, v107, s[36:37]
  v_mul_f32 v108, v100, v100
  v_fma_f32 v108, v108, s28, v109
  v_add_f32 v108, 0x3a7ba882, v108
  v_max_f32 v108, 0x3a7ba882, v108
  v_rsq_f32 v108, v108
  s_nop 0
  ds_write_b32 v4, v108 offset:32
  v_add_u32 v4, 0x400, v4
  s_waitcnt vmcnt(0) lgkmcnt(0)
  s_barrier
  s_cmp_lt_u32 s25, 4
  s_cbranch_scc1 T_LOOP
  s_endpgm
S_PRO2:
  s_cmp_lg_u32 s20, 4
  s_cbranch_scc1 S_PRO3
  s_setprio 3
  v_lshlrev_b32 v39, 4, v0
  v_add_u32 v39, 0x9000, v39
  ds_read_b128 v[112:115], v39 offset:0
  ds_read_b128 v[116:119], v39 offset:1024
  ds_read_b128 v[120:123], v39 offset:2048
  ds_read_b128 v[124:127], v39 offset:3072
  ds_read_b128 v[128:131], v39 offset:4096
  ds_read_b128 v[132:135], v39 offset:5120
  ds_read_b128 v[136:139], v39 offset:6144
  ds_read_b128 v[140:143], v39 offset:7168
  ds_read_b128 v[144:147], v39 offset:8192
  ds_read_b128 v[148:151], v39 offset:9216
  ds_read_b128 v[152:155], v39 offset:10240
  ds_read_b128 v[156:159], v39 offset:11264
  ds_read_b128 v[160:163], v39 offset:12288
  ds_read_b128 v[164:167], v39 offset:13312
  ds_read_b128 v[168:171], v39 offset:14336
  ds_read_b128 v[172:175], v39 offset:15360
  ds_read_b128 v[176:179], v39 offset:16384
  ds_read_b128 v[180:183], v39 offset:17408
  ds_read_b128 v[184:187], v39 offset:18432
  ds_read_b128 v[188:191], v39 offset:19456
  ds_read_b128 v[192:195], v39 offset:20480
  ds_read_b128 v[196:199], v39 offset:21504
  ds_read_b128 v[200:203], v39 offset:22528
  ds_read_b128 v[204:207], v39 offset:23552
  ds_read_b128 v[208:211], v39 offset:24576
  ds_read_b128 v[212:215], v39 offset:25600
  ds_read_b128 v[216:219], v39 offset:26624
  ds_read_b128 v[220:223], v39 offset:27648
  ds_read_b128 v[224:227], v39 offset:28672
  ds_read_b128 v[228:231], v39 offset:29696
  ds_read_b128 v[232:235], v39 offset:30720
  ds_read_b128 v[236:239], v39 offset:31744
  ds_read_b128 v[240:243], v39 offset:32768
  ds_read_b128 v[244:247], v39 offset:33792
  ds_read_b128 v[248:251], v39 offset:34816
  ds_read_b128 v[252:255], v39 offset:35840
  v_mov_b32 v8, 0x3f803f80
  v_mov_b32 v9, 0x3f803f80
  v_mov_b32 v10, 0x3f803f80
  v_mov_b32 v11, 0x3f803f80
  s_branch S_EXTRA
S_PRO3:
  s_setprio 0
  s_sub_u32 s60, s20, 5
  s_mov_b32 s75, 1
  s_movk_i32 s63, 0x800
  s_movk_i32 s64, 0x200
  s_mul_i32 s62, s60, 0x1800
  s_add_u32 s62, s62, 0x9000
  s_mov_b32 s65, 3
  s_lshl_b32 s44, s60, 6
  s_add_u32 s44, s44, 0x1f800
  v_add_u32 v29, s44, v22
  v_add_u32 v27, 0x1b000, v20
  v_xor_b32 v39, 16, v29
  ds_read_b64_tr_b16 v[88:89], v29 offset:0
  v_add_u32 v39, 0x300, v39
  ds_read_b128 v[224:227], v27 offset:0
  ds_read_b64_tr_b16 v[90:91], v39 offset:0
  v_xor_b32 v28, 32, v27
  ds_read_b64_tr_b16 v[92:93], v29 offset:3072
  ds_read_b64_tr_b16 v[94:95], v39 offset:3072
  ds_read_b128 v[228:231], v28 offset:0
  ds_read_b128 v[248:251], v27 offset:6144
  ds_read_b64_tr_b16 v[96:97], v29 offset:6144
  ds_read_b64_tr_b16 v[98:99], v39 offset:6144
  ds_read_b128 v[232:235], v27 offset:64
  ds_read_b128 v[252:255], v28 offset:6144
  ds_read_b64_tr_b16 v[100:101], v29 offset:9216
  ds_read_b64_tr_b16 v[102:103], v39 offset:9216
  ds_read_b128 v[236:239], v28 offset:64
  ds_read_b64_tr_b16 v[104:105], v29 offset:12288
  ds_read_b64_tr_b16 v[106:107], v39 offset:12288
  ds_read_b128 v[240:243], v27 offset:128
  ds_read_b64_tr_b16 v[108:109], v29 offset:15360
  ds_read_b64_tr_b16 v[110:111], v39 offset:15360
  ds_read_b128 v[244:247], v28 offset:128
  s_mul_i32 s48, s60, 0x1800
  v_add_u32 v8, 0, v20
  s_add_u32 s48, s48, 0
  s_mov_b32 s3, 0xbdd105ec
  v_add_u32 v10, s48, v21
  v_xor_b32 v9, 32, v8
  ds_read_b128 v[200:203], v10 offset:0
  v_xor_b32 v11, 32, v10
  ds_read_b128 v[208:211], v10 offset:64
  ds_read_b128 v[204:207], v11 offset:0
  ds_read_b128 v[212:215], v11 offset:64
  ds_read_b128 v[216:219], v10 offset:128
  ds_read_b128 v[220:223], v11 offset:128
  s_waitcnt lgkmcnt(15)
  v_mfma_f32_32x32x16_bf16 v[40:55], v[224:227], v[88:91], 0
  ds_read_b128 v[224:227], v27 offset:6208
  ds_read_b128 v[176:179], v10 offset:18432
  ds_read_b128 v[180:183], v11 offset:18432
  ds_read_b128 v[184:187], v10 offset:18496
  v_mfma_f32_32x32x16_bf16 v[56:71], v[248:251], v[88:91], 0
  ds_read_b128 v[248:251], v27 offset:12352
  ds_read_b128 v[188:191], v11 offset:18496
  ds_read_b128 v[192:195], v10 offset:18560
  ds_read_b128 v[196:199], v11 offset:18560
  s_setprio 2
  s_lshl_b32 s49, s60, 8
  s_mov_b32 s45, 0x411cc471
  s_add_u32 s49, s49, 0x25800
  v_mfma_f32_32x32x16_bf16 v[40:55], v[228:231], v[92:95], v[40:55]
  ds_read_b128 v[228:231], v28 offset:6208
  v_lshl_add_u32 v12, v25, 2, s49
  v_mfma_f32_32x32x16_bf16 v[40:55], v[232:235], v[96:99], v[40:55]
  ds_read_b128 v[232:235], v27 offset:6272
  v_mfma_f32_32x32x16_bf16 v[56:71], v[252:255], v[92:95], v[56:71]
  ds_read_b128 v[252:255], v28 offset:12352
  s_waitcnt lgkmcnt(15)
  v_mfma_f32_32x32x16_bf16 v[40:55], v[236:239], v[100:103], v[40:55]
  ds_read_b128 v[236:239], v28 offset:6272
  s_waitcnt lgkmcnt(11)
  v_mfma_f32_32x32x16_bf16 v[56:71], v[224:227], v[96:99], v[56:71]
  ds_read_b128 v[224:227], v27 offset:12416
  v_mfma_f32_32x32x16_bf16 v[40:55], v[240:243], v[104:107], v[40:55]
  ds_read_b128 v[240:243], v27 offset:12288
  s_waitcnt lgkmcnt(5)
  v_mfma_f32_32x32x16_bf16 v[56:71], v[228:231], v[100:103], v[56:71]
  ds_read_b128 v[228:231], v28 offset:12416
  v_mfma_f32_32x32x16_bf16 v[40:55], v[244:247], v[108:111], v[40:55]
  ds_read_b128 v[244:247], v28 offset:12288
  s_waitcnt lgkmcnt(6)
  v_mfma_f32_32x32x16_bf16 v[56:71], v[232:235], v[104:107], v[56:71]
  ds_read_b128 v[232:235], v8 offset:18432
  s_waitcnt lgkmcnt(5)
  v_mfma_f32_32x32x16_bf16 v[56:71], v[236:239], v[108:111], v[56:71]
  ds_read_b128 v[236:239], v9 offset:18432
  s_nop 4
  v_add_f32 v15, v40, v44
  v_add_f32 v16, v41, v45
  v_add_f32 v17, v42, v46
  v_add_f32 v18, v43, v47
  v_add_f32 v15, v15, v48
  s_waitcnt lgkmcnt(4)
  v_mfma_f32_32x32x16_bf16 v[72:87], v[240:243], v[88:91], 0
  ds_read_b128 v[240:243], v8 offset:18496
  v_add_f32 v16, v16, v49
  v_add_f32 v17, v17, v50
  v_add_f32 v18, v18, v51
  v_add_f32 v15, v15, v52
  v_add_f32 v16, v16, v53
  s_waitcnt lgkmcnt(3)
  v_mfma_f32_32x32x16_bf16 v[72:87], v[244:247], v[92:95], v[72:87]
  ds_read_b128 v[244:247], v9 offset:18496
  v_add_f32 v17, v17, v54
  v_add_f32 v18, v18, v55
  v_add_f32 v15, v15, v56
  v_add_f32 v16, v16, v57
  v_add_f32 v17, v17, v58
  s_waitcnt lgkmcnt(3)
  v_mfma_f32_32x32x16_bf16 v[160:175], v[232:235], v[200:203], 0
  ds_read_b128 v[232:235], v8 offset:24640
  v_add_f32 v18, v18, v59
  v_add_f32 v15, v15, v60
  v_add_f32 v16, v16, v61
  v_add_f32 v17, v17, v62
  v_add_f32 v18, v18, v63
  v_mfma_f32_32x32x16_bf16 v[72:87], v[248:251], v[96:99], v[72:87]
  ds_read_b128 v[248:251], v8 offset:18560
  v_add_f32 v15, v15, v64
  v_add_f32 v16, v16, v65
  v_add_f32 v17, v17, v66
  v_add_f32 v18, v18, v67
  v_add_f32 v15, v15, v68
  s_waitcnt lgkmcnt(4)
  v_mfma_f32_32x32x16_bf16 v[160:175], v[236:239], v[204:207], v[160:175]
  ds_read_b128 v[236:239], v9 offset:24640
  v_add_f32 v16, v16, v69
  v_add_f32 v17, v17, v70
  v_add_f32 v18, v18, v71
  v_mfma_f32_32x32x16_bf16 v[72:87], v[252:255], v[100:103], v[72:87]
  ds_read_b128 v[252:255], v9 offset:18560
  s_waitcnt lgkmcnt(5)
  v_mfma_f32_32x32x16_bf16 v[160:175], v[240:243], v[208:211], v[160:175]
  ds_read_b128 v[240:243], v8 offset:24704
  v_mfma_f32_32x32x16_bf16 v[72:87], v[224:227], v[104:107], v[72:87]
  ds_read_b128 v[224:227], v8 offset:24576
  s_waitcnt lgkmcnt(6)
  v_mfma_f32_32x32x16_bf16 v[160:175], v[244:247], v[212:215], v[160:175]
  ds_read_b128 v[244:247], v9 offset:24704
  v_mfma_f32_32x32x16_bf16 v[72:87], v[228:231], v[108:111], v[72:87]
  ds_read_b128 v[228:231], v9 offset:24576
  s_waitcnt lgkmcnt(6)
  v_mfma_f32_32x32x16_bf16 v[160:175], v[248:251], v[216:219], v[160:175]
  ds_read_b128 v[248:251], v8 offset:30720
  s_waitcnt lgkmcnt(5)
  v_mfma_f32_32x32x16_bf16 v[160:175], v[252:255], v[220:223], v[160:175]
  ds_read_b128 v[252:255], v9 offset:30720
  s_nop 4
  v_add_f32 v15, v15, v72
  v_add_f32 v16, v16, v73
  v_add_f32 v17, v17, v74
  v_add_f32 v18, v18, v75
  v_add_f32 v15, v15, v76
  s_waitcnt lgkmcnt(4)
  v_mfma_f32_32x32x16_bf16 v[160:175], v[224:227], v[200:203], v[160:175]
  ds_read_b128 v[224:227], v8 offset:30784
  v_add_f32 v16, v16, v77
  v_add_f32 v17, v17, v78
  v_add_f32 v18, v18, v79
  v_add_f32 v15, v15, v80
  v_add_f32 v16, v16, v81
  s_waitcnt lgkmcnt(3)
  v_mfma_f32_32x32x16_bf16 v[160:175], v[228:231], v[204:207], v[160:175]
  ds_read_b128 v[228:231], v9 offset:30784
  v_add_f32 v17, v17, v82
  v_add_f32 v18, v18, v83
  v_add_f32 v15, v15, v84
  v_add_f32 v16, v16, v85
  v_add_f32 v17, v17, v86
  v_mfma_f32_32x32x16_bf16 v[160:175], v[232:235], v[208:211], v[160:175]
  ds_read_b128 v[232:235], v8 offset:30848
  v_add_f32 v18, v18, v87
  v_add_f32 v15, v15, v16
  v_add_f32 v17, v17, v18
  v_add_f32 v15, v15, v17
  v_mfma_f32_32x32x16_bf16 v[160:175], v[236:239], v[212:215], v[160:175]
  ds_read_b128 v[236:239], v9 offset:30848
  v_mov_b32 v16, v15
  s_nop 1
  v_permlane32_swap_b32 v15, v16
  v_mfma_f32_32x32x16_bf16 v[160:175], v[240:243], v[216:219], v[160:175]
  ds_read_b128 v[240:243], v8 offset:0
  v_add_f32 v15, v15, v16
  v_mul_f32 v15, s3, v15
  v_fma_f32 v40, v40, s45, v15
  v_fma_f32 v41, v41, s45, v15
  v_mfma_f32_32x32x16_bf16 v[160:175], v[244:247], v[220:223], v[160:175]
  ds_read_b128 v[244:247], v9 offset:0
  v_fma_f32 v42, v42, s45, v15
  v_fma_f32 v43, v43, s45, v15
  v_fma_f32 v44, v44, s45, v15
  v_fma_f32 v45, v45, s45, v15
  v_fma_f32 v46, v46, s45, v15
  s_waitcnt lgkmcnt(7)
  v_mfma_f32_32x32x16_bf16 v[160:175], v[248:251], v[200:203], v[160:175]
  ds_read_b128 v[248:251], v8 offset:64
  v_fma_f32 v47, v47, s45, v15
  v_fma_f32 v48, v48, s45, v15
  v_fma_f32 v49, v49, s45, v15
  v_fma_f32 v50, v50, s45, v15
  v_fma_f32 v51, v51, s45, v15
  s_waitcnt lgkmcnt(7)
  v_mfma_f32_32x32x16_bf16 v[160:175], v[252:255], v[204:207], v[160:175]
  ds_read_b128 v[252:255], v9 offset:64
  v_fma_f32 v52, v52, s45, v15
  v_fma_f32 v53, v53, s45, v15
  v_fma_f32 v54, v54, s45, v15
  v_fma_f32 v55, v55, s45, v15
  v_fma_f32 v56, v56, s45, v15
  s_waitcnt lgkmcnt(3)
  v_mfma_f32_32x32x16_bf16 v[112:127], v[240:243], v[176:179], 0
  ds_read_b128 v[240:243], v8 offset:6208
  v_fma_f32 v57, v57, s45, v15
  v_fma_f32 v58, v58, s45, v15
  v_fma_f32 v59, v59, s45, v15
  v_fma_f32 v60, v60, s45, v15
  v_fma_f32 v61, v61, s45, v15
  v_mfma_f32_32x32x16_bf16 v[160:175], v[224:227], v[208:211], v[160:175]
  ds_read_b128 v[224:227], v8 offset:128
  v_fma_f32 v62, v62, s45, v15
  v_fma_f32 v63, v63, s45, v15
  v_fma_f32 v64, v64, s45, v15
  v_fma_f32 v65, v65, s45, v15
  v_fma_f32 v66, v66, s45, v15
  s_waitcnt lgkmcnt(4)
  v_mfma_f32_32x32x16_bf16 v[112:127], v[244:247], v[180:183], v[112:127]
  ds_read_b128 v[244:247], v9 offset:6208
  v_fma_f32 v67, v67, s45, v15
  v_fma_f32 v68, v68, s45, v15
  v_fma_f32 v69, v69, s45, v15
  v_fma_f32 v70, v70, s45, v15
  v_fma_f32 v71, v71, s45, v15
  v_mfma_f32_32x32x16_bf16 v[160:175], v[228:231], v[212:215], v[160:175]
  ds_read_b128 v[228:231], v9 offset:128
  v_fma_f32 v72, v72, s45, v15
  v_fma_f32 v73, v73, s45, v15
  v_fma_f32 v74, v74, s45, v15
  v_fma_f32 v75, v75, s45, v15
  v_fma_f32 v76, v76, s45, v15
  s_waitcnt lgkmcnt(5)
  v_mfma_f32_32x32x16_bf16 v[112:127], v[248:251], v[184:187], v[112:127]
  ds_read_b128 v[248:251], v8 offset:6272
  v_fma_f32 v77, v77, s45, v15
  v_fma_f32 v78, v78, s45, v15
  v_fma_f32 v79, v79, s45, v15
  v_fma_f32 v80, v80, s45, v15
  v_fma_f32 v81, v81, s45, v15
  v_mfma_f32_32x32x16_bf16 v[160:175], v[232:235], v[216:219], v[160:175]
  ds_read_b128 v[232:235], v8 offset:6144
  v_fma_f32 v82, v82, s45, v15
  v_fma_f32 v83, v83, s45, v15
  v_fma_f32 v84, v84, s45, v15
  v_fma_f32 v85, v85, s45, v15
  v_fma_f32 v86, v86, s45, v15
  s_waitcnt lgkmcnt(6)
  v_mfma_f32_32x32x16_bf16 v[112:127], v[252:255], v[188:191], v[112:127]
  ds_read_b128 v[252:255], v9 offset:6272
  v_fma_f32 v87, v87, s45, v15
  v_cvt_pk_bf16_f32 v88, v40, v41
  v_cvt_pk_bf16_f32 v89, v42, v43
  v_cvt_pk_bf16_f32 v90, v44, v45
  v_cvt_pk_bf16_f32 v91, v46, v47
  v_mfma_f32_32x32x16_bf16 v[160:175], v[236:239], v[220:223], v[160:175]
  ds_read_b128 v[236:239], v9 offset:6144
  v_cvt_pk_bf16_f32 v92, v48, v49
  v_cvt_pk_bf16_f32 v93, v50, v51
  v_cvt_pk_bf16_f32 v94, v52, v53
  v_cvt_pk_bf16_f32 v95, v54, v55
  v_cvt_pk_bf16_f32 v96, v56, v57
  s_waitcnt lgkmcnt(6)
  v_mfma_f32_32x32x16_bf16 v[112:127], v[224:227], v[192:195], v[112:127]
  ds_read_b128 v[224:227], v8 offset:12288
  v_cvt_pk_bf16_f32 v97, v58, v59
  v_cvt_pk_bf16_f32 v98, v60, v61
  v_cvt_pk_bf16_f32 v99, v62, v63
  v_cvt_pk_bf16_f32 v100, v64, v65
  v_cvt_pk_bf16_f32 v101, v66, v67
  s_waitcnt lgkmcnt(5)
  v_mfma_f32_32x32x16_bf16 v[112:127], v[228:231], v[196:199], v[112:127]
  ds_read_b128 v[228:231], v9 offset:12288
  v_add_f32 v13, v160, v161
  v_add_f32 v14, v162, v163
  v_add_f32 v13, v13, v164
  v_add_f32 v14, v14, v165
  v_add_f32 v13, v13, v166
  s_waitcnt lgkmcnt(4)
  v_mfma_f32_32x32x16_bf16 v[128:143], v[232:235], v[176:179], 0
  ds_read_b128 v[232:235], v8 offset:12352
  v_add_f32 v14, v14, v167
  v_add_f32 v13, v13, v168
  v_add_f32 v14, v14, v169
  v_add_f32 v13, v13, v170
  v_add_f32 v14, v14, v171
  s_waitcnt lgkmcnt(3)
  v_mfma_f32_32x32x16_bf16 v[128:143], v[236:239], v[180:183], v[128:143]
  ds_read_b128 v[236:239], v9 offset:12352
  v_add_f32 v13, v13, v172
  v_add_f32 v14, v14, v173
  v_add_f32 v13, v13, v174
  v_add_f32 v14, v14, v175
  v_cvt_pk_bf16_f32 v102, v68, v69
  s_waitcnt lgkmcnt(3)
  v_mfma_f32_32x32x16_bf16 v[144:159], v[224:227], v[176:179], 0
  v_add_f32 v13, v13, v14
  v_cvt_pk_bf16_f32 v103, v70, v71
  v_mov_b32 v14, v13
  v_cvt_pk_bf16_f32 v104, v72, v73
  v_cvt_pk_bf16_f32 v105, v74, v75
  v_permlane32_swap_b32 v13, v14
  v_mfma_f32_32x32x16_bf16 v[128:143], v[240:243], v[184:187], v[128:143]
  ds_read_b128 v[240:243], v8 offset:12416
  v_add_f32 v13, v13, v14
  v_cvt_pk_bf16_f32 v106, v76, v77
  v_mul_f32 v13, 0xbc2aaaab, v13
  v_cvt_pk_bf16_f32 v107, v78, v79
  s_waitcnt lgkmcnt(3)
  v_mfma_f32_32x32x16_bf16 v[144:159], v[228:231], v[180:183], v[144:159]
  v_cvt_pk_bf16_f32 v108, v80, v81
  v_cvt_pk_bf16_f32 v109, v82, v83
  v_cvt_pk_bf16_f32 v110, v84, v85
  v_cvt_pk_bf16_f32 v111, v86, v87
  ds_write_b32 v12, v13
  v_mfma_f32_32x32x16_bf16 v[128:143], v[244:247], v[188:191], v[128:143]
  ds_read_b128 v[244:247], v9 offset:12416
  s_waitcnt lgkmcnt(4)
  v_mfma_f32_32x32x16_bf16 v[144:159], v[232:235], v[184:187], v[144:159]
  s_waitcnt lgkmcnt(3)
  v_mfma_f32_32x32x16_bf16 v[144:159], v[236:239], v[188:191], v[144:159]
  v_mfma_f32_32x32x16_bf16 v[128:143], v[248:251], v[192:195], v[128:143]
  s_waitcnt lgkmcnt(2)
  v_mfma_f32_32x32x16_bf16 v[144:159], v[240:243], v[192:195], v[144:159]
  v_mfma_f32_32x32x16_bf16 v[128:143], v[252:255], v[196:199], v[128:143]
  s_waitcnt lgkmcnt(0)
  v_mfma_f32_32x32x16_bf16 v[144:159], v[244:247], v[196:199], v[144:159]
  s_waitcnt lgkmcnt(0)
  s_barrier
  s_setprio 0
  s_add_u32 s23, s23, 0x540
  s_add_u32 s48, s62, 0x4800
  v_add_u32 v40, s48, v24
  v_add_u32 v41, s64, v40
  v_add_u32 v42, s63, v40
  v_add_u32 v43, s63, v41
  v_add_u32 v44, s63, v42
  v_add_u32 v45, s63, v43
  ds_write_b128 v40, v[88:91]
  ds_write_b128 v41, v[92:95]
  ds_write_b128 v42, v[96:99]
  ds_write_b128 v43, v[100:103]
  ds_write_b128 v44, v[104:107]
  ds_write_b128 v45, v[108:111]
  s_branch FOLD_A2
S_EXTRA:
  v_lshlrev_b32 v53, 4, v0
  v_add_u32 v53, 0x25c00, v53
  v_lshlrev_b32 v54, 2, v0
  v_add_u32 v54, 0x26400, v54
  ds_read_b128 v[64:67], v53 offset:2304
  ds_read_b128 v[68:71], v53 offset:3328
  ds_read_b32 v72, v54 offset:2304
  ds_read_b128 v[76:79], v53 offset:4608
  ds_read_b128 v[80:83], v53 offset:5632
  ds_read_b32 v84, v54 offset:4608
  ds_read_b128 v[88:91], v53 offset:6912
  ds_read_b128 v[92:95], v53 offset:7936
  ds_read_b32 v96, v54 offset:6912
  s_waitcnt lgkmcnt(0)
  s_barrier
  s_add_u32 m0, s50, 0x1b000
  s_nop 0
  buffer_load_dwordx4 v30, s[8:11], s23 offen nt lds
  s_add_u32 m0, s50, 0x1b400
  s_nop 0
  buffer_load_dwordx4 v31, s[8:11], s23 offen nt lds
  s_add_u32 m0, s50, 0x1b800
  s_nop 0
  buffer_load_dwordx4 v32, s[8:11], s23 offen nt lds
  s_add_u32 m0, s50, 0x1bc00
  s_nop 0
  buffer_load_dwordx4 v33, s[8:11], s23 offen nt lds
  s_add_u32 m0, s50, 0x1c000
  s_nop 0
  buffer_load_dwordx4 v34, s[8:11], s23 offen nt lds
  s_add_u32 m0, s50, 0x1c400
  s_nop 0
  buffer_load_dwordx4 v35, s[8:11], s23 offen nt lds
  s_add_u32 m0, s50, 0x1c800
  s_nop 0
  buffer_load_dwordx4 v36, s[8:11], s23 offen nt lds
  s_add_u32 m0, s50, 0x1cc00
  s_nop 0
  buffer_load_dwordx4 v37, s[8:11], s23 offen nt lds
  s_add_u32 m0, s50, 0x1d000
  s_nop 0
  buffer_load_dwordx4 v38, s[8:11], s23 offen nt lds
  s_add_u32 s49, s23, 0x930000
  s_add_u32 m0, s50, 0x1d400
  s_nop 0
  buffer_load_dwordx4 v64, s[8:11], s49 offen nt lds
  s_add_u32 m0, s50, 0x1d800
  s_nop 0
  buffer_load_dwordx4 v65, s[8:11], s49 offen nt lds
  s_add_u32 m0, s50, 0x1dc00
  s_nop 0
  buffer_load_dwordx4 v66, s[8:11], s49 offen nt lds
  s_add_u32 m0, s50, 0x1e000
  s_nop 0
  buffer_load_dwordx4 v67, s[8:11], s49 offen nt lds
  s_add_u32 m0, s50, 0x1e400
  s_nop 0
  buffer_load_dwordx4 v68, s[8:11], s49 offen nt lds
  s_add_u32 m0, s50, 0x1e800
  s_nop 0
  buffer_load_dwordx4 v69, s[8:11], s49 offen nt lds
  s_add_u32 m0, s50, 0x1ec00
  s_nop 0
  buffer_load_dwordx4 v70, s[8:11], s49 offen nt lds
  s_add_u32 m0, s50, 0x1f000
  s_nop 0
  buffer_load_dwordx4 v71, s[8:11], s49 offen nt lds
  s_add_u32 m0, s50, 0x1f400
  s_nop 0
  buffer_load_dwordx4 v72, s[8:11], s49 offen nt lds
  s_add_u32 s49, s23, 0x1260000
  s_add_u32 m0, s50, 0x1f800
  s_nop 0
  buffer_load_dwordx4 v76, s[8:11], s49 offen nt lds
  s_add_u32 m0, s50, 0x1fc00
  s_nop 0
  buffer_load_dwordx4 v77, s[8:11], s49 offen nt lds
  s_add_u32 m0, s50, 0x20000
  s_nop 0
  buffer_load_dwordx4 v78, s[8:11], s49 offen nt lds
  s_add_u32 m0, s50, 0x20400
  s_nop 0
  buffer_load_dwordx4 v79, s[8:11], s49 offen nt lds
  s_add_u32 m0, s50, 0x20800
  s_nop 0
  buffer_load_dwordx4 v80, s[8:11], s49 offen nt lds
  s_add_u32 m0, s50, 0x20c00
  s_nop 0
  buffer_load_dwordx4 v81, s[8:11], s49 offen nt lds
  s_add_u32 m0, s50, 0x21000
  s_nop 0
  buffer_load_dwordx4 v82, s[8:11], s49 offen nt lds
  s_add_u32 m0, s50, 0x21400
  s_nop 0
  buffer_load_dwordx4 v83, s[8:11], s49 offen nt lds
  s_add_u32 m0, s50, 0x21800
  s_nop 0
  buffer_load_dwordx4 v84, s[8:11], s49 offen nt lds
  s_add_u32 s49, s23, 0x1b90000
  s_add_u32 m0, s50, 0x21c00
  s_nop 0
  buffer_load_dwordx4 v88, s[8:11], s49 offen nt lds
  s_add_u32 m0, s50, 0x22000
  s_nop 0
  buffer_load_dwordx4 v89, s[8:11], s49 offen nt lds
  s_add_u32 m0, s50, 0x22400
  s_nop 0
  buffer_load_dwordx4 v90, s[8:11], s49 offen nt lds
  s_add_u32 m0, s50, 0x22800
  s_nop 0
  buffer_load_dwordx4 v91, s[8:11], s49 offen nt lds
  s_add_u32 m0, s50, 0x22c00
  s_nop 0
  buffer_load_dwordx4 v92, s[8:11], s49 offen nt lds
  s_add_u32 m0, s50, 0x23000
  s_nop 0
  buffer_load_dwordx4 v93, s[8:11], s49 offen nt lds
  s_add_u32 m0, s50, 0x23400
  s_nop 0
  buffer_load_dwordx4 v94, s[8:11], s49 offen nt lds
  s_add_u32 m0, s50, 0x23800
  s_nop 0
  buffer_load_dwordx4 v95, s[8:11], s49 offen nt lds
  s_add_u32 m0, s50, 0x23c00
  s_nop 0
  buffer_load_dwordx4 v96, s[8:11], s49 offen nt lds
  s_add_u32 s23, s23, 0x540
  s_setprio 0
  v_and_b32 v53, 15, v0
  v_lshrrev_b32 v54, 4, v0
  v_and_b32 v55, 3, v53
  v_mul_u32_u24 v57, 0xc0, v53
  v_xor_b32 v58, v54, v55
  v_lshrrev_b32 v56, 2, v53
  v_lshl_add_u32 v57, v58, 4, v57
  v_add_u32 v58, 52, v54
  v_add_u32 v27, 0x24000, v57
  v_lshlrev_b32 v57, 8, v56
  ds_read_b128 v[40:43], v27 offset:0
  ds_read_b128 v[44:47], v27 offset:64
  ds_read_b128 v[48:51], v27 offset:128
  v_add_u32 v57, 48, v57
  v_cndmask_b32_e64 v57, v58, v57, s[30:31]
  v_lshlrev_b32 v57, 2, v57
  v_lshl_add_u32 v57, v55, 8, v57
  v_add_u32 v28, 0x24c00, v57
  s_waitcnt lgkmcnt(2)
  v_mfma_f32_16x16x32_bf16 v[12:15], v[8:11], v[40:43], 0
  s_waitcnt lgkmcnt(1)
  v_mfma_f32_16x16x32_bf16 v[12:15], v[8:11], v[44:47], v[12:15]
  s_waitcnt lgkmcnt(0)
  v_mfma_f32_16x16x32_bf16 v[12:15], v[8:11], v[48:51], v[12:15]
  v_mfma_f32_16x16x32_bf16 v[16:19], v[40:43], v[40:43], 0
  v_mfma_f32_16x16x32_bf16 v[16:19], v[44:47], v[44:47], v[16:19]
  v_mfma_f32_16x16x32_bf16 v[16:19], v[48:51], v[48:51], v[16:19]
  s_nop 4
  v_mul_f32 v22, v12, v12
  v_mfma_f32_16x16x32_bf16 v[52:55], v[112:115], v[40:43], 0
  v_mfma_f32_16x16x32_bf16 v[52:55], v[116:119], v[44:47], v[52:55]
  v_mfma_f32_16x16x32_bf16 v[52:55], v[120:123], v[48:51], v[52:55]
  v_cndmask_b32_e64 v21, v16, v17, s[32:33]
  v_cndmask_b32_e64 v21, v21, v18, s[34:35]
  v_mfma_f32_16x16x32_bf16 v[56:59], v[124:127], v[40:43], 0
  v_cndmask_b32_e64 v21, v21, v19, s[36:37]
  v_fma_f32 v22, v22, s28, v21
  v_mfma_f32_16x16x32_bf16 v[56:59], v[128:131], v[44:47], v[56:59]
  v_add_f32 v22, 0x3a7ba882, v22
  s_nop 0
  v_cvt_pk_bf16_f32 v52, v52, v53
  v_mfma_f32_16x16x32_bf16 v[56:59], v[132:135], v[48:51], v[56:59]
  v_cvt_pk_bf16_f32 v53, v54, v55
  v_max_f32 v22, 0x3a7ba882, v22
  v_mfma_f32_16x16x32_bf16 v[60:63], v[136:139], v[40:43], 0
  v_rsq_f32 v22, v22
  v_mfma_f32_16x16x32_bf16 v[60:63], v[140:143], v[44:47], v[60:63]
  v_mul_f32 v26, s27, v22
  v_mfma_f32_16x16x32_bf16 v[60:63], v[144:147], v[48:51], v[60:63]
  s_nop 0
  v_cvt_pk_bf16_f32 v54, v56, v57
  v_cvt_pk_bf16_f32 v55, v58, v59
  v_mfma_f32_16x16x32_bf16 v[64:67], v[148:151], v[40:43], 0
  v_mfma_f32_16x16x32_bf16 v[64:67], v[152:155], v[44:47], v[64:67]
  v_mfma_f32_16x16x32_bf16 v[64:67], v[156:159], v[48:51], v[64:67]
  s_nop 1
  v_cvt_pk_bf16_f32 v60, v60, v61
  v_cvt_pk_bf16_f32 v61, v62, v63
  v_mfma_f32_16x16x32_bf16 v[68:71], v[160:163], v[40:43], 0
  v_mfma_f32_16x16x32_bf16 v[68:71], v[164:167], v[44:47], v[68:71]
  v_mfma_f32_16x16x32_bf16 v[68:71], v[168:171], v[48:51], v[68:71]
  s_nop 0
  v_cvt_pk_bf16_f32 v62, v64, v65
  v_cvt_pk_bf16_f32 v63, v66, v67
  v_mfma_f32_16x16x32_bf16 v[72:75], v[172:175], v[40:43], 0
  v_mfma_f32_16x16x32_bf16 v[72:75], v[176:179], v[44:47], v[72:75]
  v_mfma_f32_16x16x32_bf16 v[72:75], v[180:183], v[48:51], v[72:75]
  s_nop 1
  v_cvt_pk_bf16_f32 v68, v68, v69
  v_cvt_pk_bf16_f32 v69, v70, v71
  v_mfma_f32_16x16x32_bf16 v[12:15], v[40:43], v[52:55], 0
  v_mfma_f32_16x16x32_bf16 v[12:15], v[44:47], v[60:63], v[12:15]
  s_nop 1
  v_cvt_pk_bf16_f32 v70, v72, v73
  v_cvt_pk_bf16_f32 v71, v74, v75
  s_nop 1
  v_mfma_f32_16x16x32_bf16 v[12:15], v[48:51], v[68:71], v[12:15]
  v_mfma_f32_16x16x32_bf16 v[76:79], v[40:43], v[184:187], 0
  v_mfma_f32_16x16x32_bf16 v[76:79], v[44:47], v[188:191], v[76:79]
  v_mfma_f32_16x16x32_bf16 v[76:79], v[48:51], v[192:195], v[76:79]
  s_nop 4
  v_mul_f32_dpp v12, v22, v12 quad_perm:[0,0,0,0] row_mask:0xf bank_mask:0xf
  v_mul_f32_dpp v13, v22, v13 quad_perm:[1,1,1,1] row_mask:0xf bank_mask:0xf
  v_mfma_f32_16x16x32_bf16 v[80:83], v[40:43], v[196:199], 0
  v_mul_f32_dpp v14, v22, v14 quad_perm:[2,2,2,2] row_mask:0xf bank_mask:0xf
  v_mul_f32_dpp v15, v22, v15 quad_perm:[3,3,3,3] row_mask:0xf bank_mask:0xf
  v_mfma_f32_16x16x32_bf16 v[80:83], v[44:47], v[200:203], v[80:83]
  v_max3_f32 v23, v12, v13, v14
  v_max_f32 v23, v23, v15
  v_mfma_f32_16x16x32_bf16 v[80:83], v[48:51], v[204:207], v[80:83]
  v_mul_f32 v23, v23, v26
  v_cvt_pk_bf16_f32 v100, v76, v77
  v_mfma_f32_16x16x32_bf16 v[84:87], v[40:43], v[208:211], 0
  v_fma_f32 v12, v12, v26, -v23
  v_fma_f32 v13, v13, v26, -v23
  v_mfma_f32_16x16x32_bf16 v[84:87], v[44:47], v[212:215], v[84:87]
  v_fma_f32 v14, v14, v26, -v23
  v_fma_f32 v15, v15, v26, -v23
  v_mfma_f32_16x16x32_bf16 v[84:87], v[48:51], v[216:219], v[84:87]
  v_exp_f32 v12, v12
  v_mfma_f32_16x16x32_bf16 v[88:91], v[40:43], v[220:223], 0
  v_exp_f32 v13, v13
  v_mfma_f32_16x16x32_bf16 v[88:91], v[44:47], v[224:227], v[88:91]
  v_exp_f32 v14, v14
  v_mfma_f32_16x16x32_bf16 v[88:91], v[48:51], v[228:231], v[88:91]
  v_exp_f32 v15, v15
  v_mfma_f32_16x16x32_bf16 v[92:95], v[40:43], v[232:235], 0
  v_add_f32 v20, v12, v13
  v_add_f32 v23, v14, v15
  v_mfma_f32_16x16x32_bf16 v[92:95], v[44:47], v[236:239], v[92:95]
  v_add_f32 v20, v20, v23
  v_mul_f32_dpp v12, v22, v12 quad_perm:[0,0,0,0] row_mask:0xf bank_mask:0xf
  v_mfma_f32_16x16x32_bf16 v[92:95], v[48:51], v[240:243], v[92:95]
  v_rcp_f32 v20, v20
  v_mfma_f32_16x16x32_bf16 v[96:99], v[40:43], v[244:247], 0
  v_mul_f32_dpp v13, v22, v13 quad_perm:[1,1,1,1] row_mask:0xf bank_mask:0xf
  v_mul_f32_dpp v14, v22, v14 quad_perm:[2,2,2,2] row_mask:0xf bank_mask:0xf
  v_mfma_f32_16x16x32_bf16 v[96:99], v[44:47], v[248:251], v[96:99]
  v_mul_f32_dpp v15, v22, v15 quad_perm:[3,3,3,3] row_mask:0xf bank_mask:0xf
  v_cndmask_b32_e64 v20, 0, v20, s[30:31]
  v_mfma_f32_16x16x32_bf16 v[96:99], v[48:51], v[252:255], v[96:99]
  v_mul_f32 v12, v12, v20
  v_mul_f32 v13, v13, v20
  v_mul_f32 v14, v14, v20
  v_mul_f32 v15, v15, v20
  v_cvt_pk_bf16_f32 v101, v78, v79
  v_cvt_pk_bf16_f32 v24, v12, v13
  v_cvt_pk_bf16_f32 v25, v14, v15
  v_lshlrev_b32 v76, 16, v40
  v_and_b32 v77, 0xffff0000, v40
  v_lshlrev_b32 v78, 16, v41
  v_and_b32 v79, 0xffff0000, v41
  v_cvt_pk_bf16_f32 v102, v80, v81
  v_cvt_pk_bf16_f32 v103, v82, v83
  v_mfma_f32_16x16x16_bf16 v[76:79], v[100:101], v[24:25], v[76:79]
  v_lshlrev_b32 v80, 16, v42
  v_and_b32 v81, 0xffff0000, v42
  v_lshlrev_b32 v82, 16, v43
  v_and_b32 v83, 0xffff0000, v43
  v_cvt_pk_bf16_f32 v104, v84, v85
  v_cvt_pk_bf16_f32 v105, v86, v87
  v_mfma_f32_16x16x16_bf16 v[80:83], v[102:103], v[24:25], v[80:83]
  v_lshlrev_b32 v84, 16, v44
  v_and_b32 v85, 0xffff0000, v44
  v_lshlrev_b32 v86, 16, v45
  v_and_b32 v87, 0xffff0000, v45
  v_cvt_pk_bf16_f32 v106, v88, v89
  v_cvt_pk_bf16_f32 v107, v90, v91
  v_mfma_f32_16x16x16_bf16 v[84:87], v[104:105], v[24:25], v[84:87]
  v_lshlrev_b32 v88, 16, v46
  v_and_b32 v89, 0xffff0000, v46
  v_lshlrev_b32 v90, 16, v47
  v_and_b32 v91, 0xffff0000, v47
  v_cvt_pk_bf16_f32 v108, v92, v93
  v_cvt_pk_bf16_f32 v109, v94, v95
  v_mfma_f32_16x16x16_bf16 v[88:91], v[106:107], v[24:25], v[88:91]
  v_lshlrev_b32 v92, 16, v48
  v_and_b32 v93, 0xffff0000, v48
  v_lshlrev_b32 v94, 16, v49
  v_and_b32 v95, 0xffff0000, v49
  v_cvt_pk_bf16_f32 v110, v96, v97
  v_cvt_pk_bf16_f32 v111, v98, v99
  v_mfma_f32_16x16x16_bf16 v[92:95], v[108:109], v[24:25], v[92:95]
  v_lshlrev_b32 v96, 16, v50
  v_and_b32 v97, 0xffff0000, v50
  v_lshlrev_b32 v98, 16, v51
  v_and_b32 v99, 0xffff0000, v51
  v_cvt_pk_bf16_f32 v76, v76, v77
  v_cvt_pk_bf16_f32 v77, v78, v79
  v_mfma_f32_16x16x16_bf16 v[96:99], v[110:111], v[24:25], v[96:99]
  v_cvt_pk_bf16_f32 v78, v80, v81
  v_cvt_pk_bf16_f32 v79, v82, v83
  v_cvt_pk_bf16_f32 v84, v84, v85
  v_cvt_pk_bf16_f32 v85, v86, v87
  v_mfma_f32_16x16x32_bf16 v[100:103], v[8:11], v[76:79], 0
  v_cvt_pk_bf16_f32 v86, v88, v89
  v_cvt_pk_bf16_f32 v87, v90, v91
  v_cvt_pk_bf16_f32 v92, v92, v93
  v_cvt_pk_bf16_f32 v93, v94, v95
  v_mfma_f32_16x16x32_bf16 v[100:103], v[8:11], v[84:87], v[100:103]
  v_cvt_pk_bf16_f32 v94, v96, v97
  v_cvt_pk_bf16_f32 v95, v98, v99
  ds_write_b128 v27, v[76:79] offset:0
  s_nop 0
  v_mfma_f32_16x16x32_bf16 v[100:103], v[8:11], v[92:95], v[100:103]
  ds_write_b128 v27, v[84:87] offset:64
  v_mfma_f32_16x16x32_bf16 v[104:107], v[76:79], v[76:79], 0
  ds_write_b128 v27, v[92:95] offset:128
  v_mfma_f32_16x16x32_bf16 v[104:107], v[84:87], v[84:87], v[104:107]
  v_mfma_f32_16x16x32_bf16 v[104:107], v[92:95], v[92:95], v[104:107]
  s_nop 2
  v_mul_f32 v108, v100, v100
  s_nop 3
  v_cndmask_b32_e64 v109, v104, v105, s[32:33]
  v_cndmask_b32_e64 v109, v109, v106, s[34:35]
  v_cndmask_b32_e64 v109, v109, v107, s[36:37]
  v_fma_f32 v108, v108, s28, v109
  v_add_f32 v108, 0x3a7ba882, v108
  v_max_f32 v108, 0x3a7ba882, v108
  v_rsq_f32 v108, v108
  s_nop 0
  ds_write_b32 v28, v108 offset:0
  s_waitcnt lgkmcnt(0)
S_R0_DONE:
  v_lshlrev_b32 v27, 4, v0
  v_cmp_gt_u32_e64 s[48:49], 12, v0
  v_xor_b32 v0, s21, v0
  v_mov_b32 v58, 0x80000000
  v_lshlrev_b32 v0, 4, v0
  v_add_u32 v0, 0x3f480, v0
  v_cndmask_b32_e64 v0, v58, v0, s[48:49]
  s_waitcnt vmcnt(0) lgkmcnt(0)
  s_barrier
  s_mov_b32 s25, 1
  s_setprio 2
S_LOOP:
  s_setprio 2
  ds_read_b128 v[20:23], v1 offset:0
  ds_read_b128 v[68:71], v7 offset:0
  v_xor_b32 v116, 32, v1
  ds_read_b128 v[72:75], v7 offset:1024
  ds_read_b128 v[24:27], v116 offset:0
  ds_read_b128 v[28:31], v1 offset:64
  ds_read_b128 v[76:79], v7 offset:2048
  ds_read_b128 v[32:35], v116 offset:64
  ds_read_b128 v[80:83], v7 offset:3072
  ds_read_b128 v[36:39], v1 offset:128
  ds_read_b128 v[84:87], v7 offset:4096
  ds_read_b128 v[40:43], v116 offset:128
  ds_read_b128 v[88:91], v7 offset:5120
  v_add_u32 v117, 0x1800, v1
  v_add_u32 v119, s42, v7
  v_cndmask_b32_e64 v117, v117, v2, s[40:41]
  ds_read_b128 v[104:107], v119
  v_xor_b32 v118, 32, v117
  ds_read_b128 v[44:47], v117 offset:0
  ds_read_b128 v[48:51], v118 offset:0
  ds_read_b128 v[52:55], v117 offset:64
  ds_read_b128 v[56:59], v118 offset:64
  ds_read_b128 v[60:63], v117 offset:128
  ds_read_b128 v[64:67], v118 offset:128
  v_subrev_u32 v120, 0x9000, v7
  ds_read_b128 v[108:111], v119 offset:1024
  v_lshrrev_b32 v120, 2, v120
  s_cmp_lt_u32 s25, 3
  v_add_u32 v156, s73, v7
  v_add_u32 v120, s43, v120
  s_cselect_b32 s70, s10, 0
  s_and_b32 s49, s25, 1
  ds_read_b32 v112, v120
  s_waitcnt lgkmcnt(15)
  v_mfma_f32_32x32x16_bf16 v[196:211], v[68:71], v[20:23], 0
  ds_read_b128 v[68:71], v7 offset:6144
  s_xor_b32 s49, s49, 1
  ds_read_b128 v[92:95], v156 offset:6144
  s_mul_i32 s49, s49, 0x9000
  v_subrev_u32 v157, 0x300, v5
  s_add_u32 s51, s49, s50
  ds_read_b128 v[96:99], v156 offset:7168
  s_add_u32 s51, s51, 0x12000
  v_mfma_f32_32x32x16_bf16 v[196:211], v[72:75], v[24:27], v[196:211]
  ds_read_b128 v[72:75], v7 offset:7168
  s_sub_u32 s72, s50, s51
  ds_read_b128 v[100:103], v156 offset:8192
  s_cmp_gt_u32 s25, 1
  ds_read_b128 v[228:231], v3 offset:0
  s_cselect_b32 s78, s14, 0
  s_sub_u32 s74, s24, 0x540
  ds_read_b128 v[232:235], v3 offset:32
  v_mfma_f32_32x32x16_bf16 v[196:211], v[76:79], v[28:31], v[196:211]
  ds_read_b128 v[76:79], v7 offset:8192
  s_cmp_lt_u32 s25, 4
  ds_read_b128 v[236:239], v3 offset:64
  s_cselect_b64 vcc, -1, 0
  s_add_u32 m0, s51, 0
  ds_read_b128 v[240:243], v3 offset:96
  s_waitcnt lgkmcnt(12)
  buffer_load_dwordx4 v104, s[68:71], s23 offen nt lds
  v_mfma_f32_32x32x16_bf16 v[196:211], v[80:83], v[32:35], v[196:211]
  ds_read_b128 v[80:83], v7 offset:9216
  s_add_u32 m0, s51, 0x400
  ds_read_b128 v[244:247], v3 offset:128
  ds_read_b128 v[248:251], v3 offset:160
  ds_read_b128 v[252:255], v3 offset:192
  ds_read_b32 v8, v4
  v_add_u32 v18, s72, v1
  v_mfma_f32_32x32x16_bf16 v[196:211], v[84:87], v[36:39], v[196:211]
  ds_read_b128 v[84:87], v7 offset:10240
  v_xor_b32 v19, 32, v18
  ds_read_b32 v9, v6
  v_add_u32 v1, s26, v1
  v_add_u32 v3, 0x400, v3
  v_add_u32 v4, 0x400, v4
  v_mfma_f32_32x32x16_bf16 v[196:211], v[88:91], v[40:43], v[196:211]
  ds_read_b128 v[88:91], v7 offset:11264
  v_add_u32 v6, 0x400, v6
  v_add_u32 v5, 0x300, v5
  buffer_load_dwordx4 v105, s[68:71], s23 offen nt lds
  s_waitcnt lgkmcnt(15)
  v_mfma_f32_32x32x16_bf16 v[212:227], v[68:71], v[20:23], 0
  ds_read_b128 v[68:71], v7 offset:12288
  s_add_u32 m0, s51, 0x800
  s_waitcnt lgkmcnt(15)
  v_mfma_f32_32x32x16_bf16 v[212:227], v[72:75], v[24:27], v[212:227]
  ds_read_b128 v[72:75], v7 offset:13312
  s_nop 0
  v_cvt_pk_bf16_f32 v116, v196, v197
  v_cvt_pk_bf16_f32 v117, v198, v199
  v_cvt_pk_bf16_f32 v118, v200, v201
  v_cvt_pk_bf16_f32 v119, v202, v203
  v_cvt_pk_bf16_f32 v120, v204, v205
  s_waitcnt lgkmcnt(12)
  v_mfma_f32_32x32x16_bf16 v[212:227], v[76:79], v[28:31], v[212:227]
  ds_read_b128 v[76:79], v7 offset:14336
  v_cvt_pk_bf16_f32 v121, v206, v207
  v_cvt_pk_bf16_f32 v122, v208, v209
  v_cvt_pk_bf16_f32 v123, v210, v211
  buffer_load_dwordx4 v106, s[68:71], s23 offen nt lds
  s_waitcnt lgkmcnt(10)
  v_mfma_f32_32x32x16_bf16 v[212:227], v[80:83], v[32:35], v[212:227]
  ds_read_b128 v[80:83], v7 offset:15360
  s_add_u32 m0, s51, 0xc00
  s_waitcnt lgkmcnt(7)
  v_mul_f32 v8, s27, v8
  s_waitcnt lgkmcnt(5)
  v_mul_f32 v9, s27, v9
  v_mfma_f32_32x32x16_bf16 v[212:227], v[84:87], v[36:39], v[212:227]
  ds_read_b128 v[84:87], v7 offset:16384
  s_waitcnt lgkmcnt(5)
  v_mfma_f32_32x32x16_bf16 v[212:227], v[88:91], v[40:43], v[212:227]
  ds_read_b128 v[88:91], v7 offset:17408
  buffer_load_dwordx4 v107, s[68:71], s23 offen nt lds
  s_waitcnt lgkmcnt(5)
  v_mfma_f32_32x32x16_bf16 v[196:211], v[68:71], v[20:23], 0
  s_add_u32 m0, s51, 0x1000
  ds_read_b128 v[68:71], v7 offset:0
  s_waitcnt lgkmcnt(5)
  v_mfma_f32_32x32x16_bf16 v[196:211], v[72:75], v[24:27], v[196:211]
  s_nop 3
  v_cvt_pk_bf16_f32 v124, v212, v213
  v_cvt_pk_bf16_f32 v125, v214, v215
  v_cvt_pk_bf16_f32 v126, v216, v217
  v_cvt_pk_bf16_f32 v127, v218, v219
  v_cvt_pk_bf16_f32 v128, v220, v221
  v_cvt_pk_bf16_f32 v129, v222, v223
  s_waitcnt lgkmcnt(4)
  v_mfma_f32_32x32x16_bf16 v[196:211], v[76:79], v[28:31], v[196:211]
  v_cvt_pk_bf16_f32 v130, v224, v225
  v_cvt_pk_bf16_f32 v131, v226, v227
  ds_read_b128 v[72:75], v7 offset:1024
  buffer_load_dwordx4 v108, s[68:71], s23 offen nt lds
  s_add_u32 m0, s51, 0x1400
  s_waitcnt lgkmcnt(4)
  v_mfma_f32_32x32x16_bf16 v[196:211], v[80:83], v[32:35], v[196:211]
  ds_read_b128 v[76:79], v7 offset:2048
  ds_read_b128 v[80:83], v7 offset:3072
  s_waitcnt lgkmcnt(5)
  v_mfma_f32_32x32x16_bf16 v[196:211], v[84:87], v[36:39], v[196:211]
  ds_read_b128 v[84:87], v7 offset:4096
  s_waitcnt lgkmcnt(5)
  v_mfma_f32_32x32x16_bf16 v[196:211], v[88:91], v[40:43], v[196:211]
  ds_read_b128 v[88:91], v7 offset:5120
  buffer_load_dwordx4 v109, s[68:71], s23 offen nt lds
  s_add_u32 m0, s51, 0x1800
  v_mfma_f32_32x32x16_bf16 v[164:179], v[20:23], v[116:119], 0
  v_mfma_f32_32x32x16_bf16 v[164:179], v[24:27], v[120:123], v[164:179]
  s_nop 6
  v_cvt_pk_bf16_f32 v132, v196, v197
  v_cvt_pk_bf16_f32 v133, v198, v199
  v_cvt_pk_bf16_f32 v134, v200, v201
  v_cvt_pk_bf16_f32 v135, v202, v203
  v_cvt_pk_bf16_f32 v136, v204, v205
  v_cvt_pk_bf16_f32 v137, v206, v207
  v_mfma_f32_32x32x16_bf16 v[164:179], v[28:31], v[124:127], v[164:179]
  v_cvt_pk_bf16_f32 v138, v208, v209
  v_cvt_pk_bf16_f32 v139, v210, v211
  buffer_load_dwordx4 v110, s[68:71], s23 offen nt lds
  s_add_u32 m0, s51, 0x1c00
  v_mfma_f32_32x32x16_bf16 v[164:179], v[32:35], v[128:131], v[164:179]
  v_mfma_f32_32x32x16_bf16 v[164:179], v[36:39], v[132:135], v[164:179]
  v_mfma_f32_32x32x16_bf16 v[164:179], v[40:43], v[136:139], v[164:179]
  buffer_load_dwordx4 v111, s[68:71], s23 offen nt lds
  s_add_u32 m0, s51, 0x2000
  v_mfma_f32_32x32x16_bf16 v[180:195], v[44:47], v[116:119], 0
  v_mfma_f32_32x32x16_bf16 v[180:195], v[48:51], v[120:123], v[180:195]
  s_nop 7
  v_mul_f32 v164, v164, v228
  v_mul_f32 v165, v165, v229
  v_mul_f32 v166, v166, v230
  v_mul_f32 v167, v167, v231
  v_mul_f32 v168, v168, v232
  v_mul_f32 v169, v169, v233
  v_mfma_f32_32x32x16_bf16 v[180:195], v[52:55], v[124:127], v[180:195]
  v_mul_f32 v170, v170, v234
  v_mul_f32 v171, v171, v235
  v_max3_f32 v10, v164, v165, v166
  buffer_load_dwordx4 v112, s[68:71], s23 offen nt lds
  v_mfma_f32_32x32x16_bf16 v[180:195], v[56:59], v[128:131], v[180:195]
  v_mul_f32 v172, v172, v236
  v_mul_f32 v173, v173, v237
  v_mul_f32 v174, v174, v238
  v_mul_f32 v175, v175, v239
  v_max3_f32 v11, v167, v168, v169
  v_max3_f32 v10, v10, v170, v171
  v_mfma_f32_32x32x16_bf16 v[180:195], v[60:63], v[132:135], v[180:195]
  v_mul_f32 v176, v176, v240
  v_mul_f32 v177, v177, v241
  v_mul_f32 v178, v178, v242
  v_mul_f32 v179, v179, v243
  v_max3_f32 v11, v11, v172, v173
  v_max3_f32 v10, v10, v174, v175
  v_mfma_f32_32x32x16_bf16 v[180:195], v[64:67], v[136:139], v[180:195]
  v_max3_f32 v11, v11, v176, v177
  v_max3_f32 v10, v10, v178, v179
  s_add_u32 s23, s23, 0x540
  buffer_store_dwordx4 v[92:95], v110, s[76:79], s74 offen sc0 sc1
  s_sub_u32 s26, 0, s26
  s_waitcnt lgkmcnt(5)
  v_mfma_f32_32x32x16_bf16 v[196:211], v[68:71], v[44:47], 0
  ds_read_b128 v[68:71], v7 offset:6144
  ds_read_b128 v[92:95], v157
  s_waitcnt lgkmcnt(6)
  v_mfma_f32_32x32x16_bf16 v[196:211], v[72:75], v[48:51], v[196:211]
  ds_read_b128 v[72:75], v7 offset:7168
  v_mul_f32 v180, v180, v244
  v_mul_f32 v181, v181, v245
  v_mul_f32 v182, v182, v246
  v_mul_f32 v183, v183, v247
  v_mul_f32 v184, v184, v248
  s_waitcnt lgkmcnt(6)
  v_mfma_f32_32x32x16_bf16 v[196:211], v[76:79], v[52:55], v[196:211]
  ds_read_b128 v[76:79], v7 offset:8192
  v_mul_f32 v185, v185, v249
  v_mul_f32 v186, v186, v250
  v_mul_f32 v187, v187, v251
  buffer_store_dwordx4 v[96:99], v111, s[76:79], s74 offen sc0 sc1
  s_waitcnt lgkmcnt(6)
  v_mfma_f32_32x32x16_bf16 v[196:211], v[80:83], v[56:59], v[196:211]
  ds_read_b128 v[80:83], v7 offset:9216
  v_mul_f32 v188, v188, v252
  v_max3_f32 v11, v11, v180, v181
  v_max3_f32 v10, v10, v182, v183
  v_cndmask_b32_e64 v188, v188, v187, s[38:39]
  v_max3_f32 v11, v11, v184, v185
  s_waitcnt lgkmcnt(6)
  v_mfma_f32_32x32x16_bf16 v[196:211], v[84:87], v[60:63], v[196:211]
  ds_read_b128 v[84:87], v7 offset:10240
  v_max3_f32 v10, v10, v186, v187
  v_and_b32 v189, 0xffff0000, v24
  v_max3_f32 v10, v10, v11, v188
  v_lshlrev_b32 v190, 16, v25
  v_mov_b32 v11, v10
  s_waitcnt lgkmcnt(6)
  v_mfma_f32_32x32x16_bf16 v[196:211], v[88:91], v[64:67], v[196:211]
  ds_read_b128 v[88:91], v7 offset:11264
  v_permlane32_swap_b32 v10, v11
  v_max_f32 v10, v10, v11
  v_and_b32 v191, 0xffff0000, v25
  s_waitcnt lgkmcnt(5)
  buffer_store_dwordx4 v[92:95], v0, s[76:79], s74 offen sc0 sc1
  v_mfma_f32_32x32x16_bf16 v[212:227], v[68:71], v[44:47], 0
  ds_read_b128 v[68:71], v7 offset:12288
  v_mul_f32 v10, v10, v8
  v_lshlrev_b32 v192, 16, v26
  v_fma_f32 v164, v164, v8, -v10
  v_fma_f32 v165, v165, v8, -v10
  v_fma_f32 v166, v166, v8, -v10
  s_waitcnt lgkmcnt(5)
  v_mfma_f32_32x32x16_bf16 v[212:227], v[72:75], v[48:51], v[212:227]
  ds_read_b128 v[72:75], v7 offset:13312
  v_cvt_pk_bf16_f32 v140, v196, v197
  v_cvt_pk_bf16_f32 v141, v198, v199
  v_cvt_pk_bf16_f32 v142, v200, v201
  v_cvt_pk_bf16_f32 v143, v202, v203
  v_cvt_pk_bf16_f32 v144, v204, v205
  s_waitcnt lgkmcnt(5)
  v_mfma_f32_32x32x16_bf16 v[212:227], v[76:79], v[52:55], v[212:227]
  ds_read_b128 v[76:79], v7 offset:14336
  v_cvt_pk_bf16_f32 v145, v206, v207
  v_cvt_pk_bf16_f32 v146, v208, v209
  v_cvt_pk_bf16_f32 v147, v210, v211
  v_fma_f32 v167, v167, v8, -v10
  v_fma_f32 v168, v168, v8, -v10
  s_waitcnt lgkmcnt(5)
  v_mfma_f32_32x32x16_bf16 v[212:227], v[80:83], v[56:59], v[212:227]
  ds_read_b128 v[80:83], v7 offset:15360
  v_exp_f32 v164, v164
  v_exp_f32 v165, v165
  v_fma_f32 v169, v169, v8, -v10
  s_waitcnt lgkmcnt(5)
  v_mfma_f32_32x32x16_bf16 v[212:227], v[84:87], v[60:63], v[212:227]
  ds_read_b128 v[84:87], v7 offset:16384
  v_fma_f32 v170, v170, v8, -v10
  v_exp_f32 v166, v166
  v_exp_f32 v167, v167
  s_waitcnt lgkmcnt(5)
  v_mfma_f32_32x32x16_bf16 v[212:227], v[88:91], v[64:67], v[212:227]
  ds_read_b128 v[88:91], v7 offset:17408
  v_exp_f32 v168, v168
  v_fma_f32 v171, v171, v8, -v10
  v_fma_f32 v172, v172, v8, -v10
  v_exp_f32 v169, v169
  s_waitcnt lgkmcnt(5)
  v_mfma_f32_32x32x16_bf16 v[196:211], v[68:71], v[44:47], 0
  v_exp_f32 v170, v170
  v_add_f32 v13, v164, v165
  v_fma_f32 v173, v173, v8, -v10
  v_fma_f32 v174, v174, v8, -v10
  v_exp_f32 v171, v171
  s_waitcnt lgkmcnt(4)
  v_mfma_f32_32x32x16_bf16 v[196:211], v[72:75], v[48:51], v[196:211]
  v_cvt_pk_bf16_f32 v148, v212, v213
  v_cvt_pk_bf16_f32 v149, v214, v215
  v_cvt_pk_bf16_f32 v150, v216, v217
  v_cvt_pk_bf16_f32 v151, v218, v219
  v_cvt_pk_bf16_f32 v152, v220, v221
  v_cvt_pk_bf16_f32 v153, v222, v223
  s_waitcnt lgkmcnt(3)
  v_mfma_f32_32x32x16_bf16 v[196:211], v[76:79], v[52:55], v[196:211]
  v_cvt_pk_bf16_f32 v154, v224, v225
  v_cvt_pk_bf16_f32 v155, v226, v227
  v_exp_f32 v172, v172
  v_add_f32 v12, v166, v167
  v_add_f32 v13, v13, v168
  s_waitcnt lgkmcnt(2)
  v_mfma_f32_32x32x16_bf16 v[196:211], v[80:83], v[56:59], v[196:211]
  v_fma_f32 v175, v175, v8, -v10
  v_fma_f32 v176, v176, v8, -v10
  v_exp_f32 v173, v173
  v_exp_f32 v174, v174
  s_waitcnt lgkmcnt(1)
  v_mfma_f32_32x32x16_bf16 v[196:211], v[84:87], v[60:63], v[196:211]
  v_add_f32 v12, v12, v169
  v_add_f32 v13, v13, v170
  v_fma_f32 v177, v177, v8, -v10
  v_fma_f32 v178, v178, v8, -v10
  v_exp_f32 v175, v175
  s_waitcnt lgkmcnt(0)
  v_mfma_f32_32x32x16_bf16 v[196:211], v[88:91], v[64:67], v[196:211]
  v_exp_f32 v176, v176
  v_add_f32 v12, v12, v171
  v_add_f32 v13, v13, v172
  v_fma_f32 v179, v179, v8, -v10
  v_fma_f32 v180, v180, v8, -v10
  v_exp_f32 v177, v177
  v_exp_f32 v178, v178
  v_add_f32 v12, v12, v173
  v_add_f32 v13, v13, v174
  v_fma_f32 v181, v181, v8, -v10
  v_fma_f32 v182, v182, v8, -v10
  v_exp_f32 v179, v179
  v_cvt_pk_bf16_f32 v156, v196, v197
  v_cvt_pk_bf16_f32 v157, v198, v199
  v_cvt_pk_bf16_f32 v158, v200, v201
  v_cvt_pk_bf16_f32 v159, v202, v203
  v_cvt_pk_bf16_f32 v160, v204, v205
  v_cvt_pk_bf16_f32 v161, v206, v207
  v_cvt_pk_bf16_f32 v162, v208, v209
  v_cvt_pk_bf16_f32 v163, v210, v211
  v_mfma_f32_32x32x16_bf16 v[196:211], v[20:23], v[140:143], 0
  v_exp_f32 v180, v180
  v_add_f32 v12, v12, v175
  v_add_f32 v13, v13, v176
  v_fma_f32 v183, v183, v8, -v10
  v_fma_f32 v184, v184, v8, -v10
  v_mfma_f32_32x32x16_bf16 v[196:211], v[24:27], v[144:147], v[196:211]
  v_exp_f32 v181, v181
  v_exp_f32 v182, v182
  v_add_f32 v12, v12, v177
  v_add_f32 v13, v13, v178
  v_mfma_f32_32x32x16_bf16 v[196:211], v[28:31], v[148:151], v[196:211]
  v_fma_f32 v185, v185, v8, -v10
  v_fma_f32 v186, v186, v8, -v10
  v_fma_f32 v188, v188, v8, -v10
  v_exp_f32 v183, v183
  v_exp_f32 v184, v184
  v_mfma_f32_32x32x16_bf16 v[196:211], v[32:35], v[152:155], v[196:211]
  v_add_f32 v12, v12, v179
  v_add_f32 v13, v13, v180
  v_fma_f32 v187, v187, v8, -v10
  v_exp_f32 v185, v185
  v_exp_f32 v186, v186
  v_mfma_f32_32x32x16_bf16 v[196:211], v[36:39], v[156:159], v[196:211]
  v_exp_f32 v188, v188
  v_add_f32 v12, v12, v181
  v_add_f32 v13, v13, v182
  v_exp_f32 v187, v187
  v_mfma_f32_32x32x16_bf16 v[196:211], v[40:43], v[160:163], v[196:211]
  v_add_f32 v12, v12, v183
  v_add_f32 v13, v13, v184
  v_cndmask_b32_e64 v188, v188, 0, s[38:39]
  v_add_f32 v12, v12, v185
  v_add_f32 v13, v13, v186
  v_add_f32 v12, v12, v187
  v_mfma_f32_32x32x16_bf16 v[212:227], v[44:47], v[140:143], 0
  v_add_f32 v13, v13, v188
  v_mul_f32 v164, v164, v228
  v_add_f32 v13, v13, v12
  v_mul_f32 v165, v165, v229
  v_mov_b32 v12, v13
  v_mul_f32 v166, v166, v230
  v_mfma_f32_32x32x16_bf16 v[212:227], v[48:51], v[144:147], v[212:227]
  v_permlane32_swap_b32 v13, v12
  v_add_f32 v13, v13, v12
  v_mul_f32 v167, v167, v231
  v_rcp_f32 v13, v13
  v_mfma_f32_32x32x16_bf16 v[212:227], v[52:55], v[148:151], v[212:227]
  ds_read_b128 v[148:151], v7 offset:18432
  v_mul_f32 v168, v168, v232
  v_mul_f32 v169, v169, v233
  v_mul_f32 v170, v170, v234
  v_mul_f32 v171, v171, v235
  v_mul_f32 v172, v172, v236
  v_mfma_f32_32x32x16_bf16 v[212:227], v[56:59], v[152:155], v[212:227]
  ds_read_b128 v[152:155], v7 offset:19456
  v_mul_f32 v173, v173, v237
  v_mul_f32 v174, v174, v238
  v_mul_f32 v175, v175, v239
  v_mul_f32 v176, v176, v240
  v_mul_f32 v177, v177, v241
  v_mfma_f32_32x32x16_bf16 v[212:227], v[60:63], v[156:159], v[212:227]
  ds_read_b128 v[156:159], v7 offset:20480
  v_mul_f32 v180, v180, v244
  v_mul_f32 v181, v181, v245
  v_mul_f32 v182, v182, v246
  v_mul_f32 v183, v183, v247
  v_mul_f32 v184, v184, v248
  v_mfma_f32_32x32x16_bf16 v[212:227], v[64:67], v[160:163], v[212:227]
  ds_read_b128 v[160:163], v7 offset:21504
  v_mul_f32 v185, v185, v249
  v_mul_f32 v186, v186, v250
  v_mul_f32 v187, v187, v251
  v_mul_f32 v188, v188, v252
  v_mul_f32 v164, v164, v13
  s_waitcnt lgkmcnt(3)
  v_mfma_f32_32x32x16_bf16 v[116:131], v[20:23], v[148:151], 0
  v_mul_f32 v165, v165, v13
  v_mul_f32 v166, v166, v13
  v_mul_f32 v167, v167, v13
  v_mul_f32 v168, v168, v13
  v_mul_f32 v169, v169, v13
  v_mul_f32 v170, v170, v13
  v_mfma_f32_32x32x16_bf16 v[132:147], v[44:47], v[148:151], 0
  ds_read_b128 v[148:151], v7 offset:22528
  v_mul_f32 v171, v171, v13
  v_mul_f32 v172, v172, v13
  v_mul_f32 v173, v173, v13
  v_mul_f32 v174, v174, v13
  v_mul_f32 v175, v175, v13
  s_waitcnt lgkmcnt(3)
  v_mfma_f32_32x32x16_bf16 v[116:131], v[24:27], v[152:155], v[116:131]
  v_mul_f32 v176, v176, v13
  v_mul_f32 v177, v177, v13
  v_mul_f32 v180, v180, v13
  s_setprio 0
  v_mul_f32 v181, v181, v13
  v_mul_f32 v182, v182, v13
  v_mul_f32 v183, v183, v13
  v_mfma_f32_32x32x16_bf16 v[132:147], v[48:51], v[152:155], v[132:147]
  ds_read_b128 v[152:155], v7 offset:23552
  v_mul_f32 v184, v184, v13
  v_mul_f32 v185, v185, v13
  v_mul_f32 v186, v186, v13
  v_mul_f32 v187, v187, v13
  v_mul_f32 v188, v188, v13
  s_waitcnt lgkmcnt(3)
  v_mfma_f32_32x32x16_bf16 v[116:131], v[28:31], v[156:159], v[116:131]
  v_cvt_pk_bf16_f32 v164, v164, v165
  v_cvt_pk_bf16_f32 v165, v166, v167
  v_cvt_pk_bf16_f32 v166, v168, v169
  v_cvt_pk_bf16_f32 v167, v170, v171
  v_cvt_pk_bf16_f32 v168, v172, v173
  v_cvt_pk_bf16_f32 v169, v174, v175
  v_mfma_f32_32x32x16_bf16 v[132:147], v[52:55], v[156:159], v[132:147]
  ds_read_b128 v[156:159], v7 offset:24576
  v_cvt_pk_bf16_f32 v170, v176, v177
  v_cvt_pk_bf16_f32 v172, v180, v181
  v_cvt_pk_bf16_f32 v173, v182, v183
  v_cvt_pk_bf16_f32 v174, v184, v185
  v_cvt_pk_bf16_f32 v175, v186, v187
  s_waitcnt lgkmcnt(3)
  v_mfma_f32_32x32x16_bf16 v[116:131], v[32:35], v[160:163], v[116:131]
  v_cvt_pk_bf16_f32 v176, v188, 0
  v_lshlrev_b32 v180, 16, v20
  v_and_b32 v181, 0xffff0000, v20
  v_lshlrev_b32 v182, 16, v21
  v_and_b32 v183, 0xffff0000, v21
  v_lshlrev_b32 v184, 16, v22
  v_mfma_f32_32x32x16_bf16 v[132:147], v[56:59], v[160:163], v[132:147]
  ds_read_b128 v[160:163], v7 offset:25600
  v_and_b32 v185, 0xffff0000, v22
  v_lshlrev_b32 v186, 16, v23
  v_and_b32 v187, 0xffff0000, v23
  v_lshlrev_b32 v188, 16, v24
  v_and_b32 v193, 0xffff0000, v26
  s_waitcnt lgkmcnt(3)
  v_mfma_f32_32x32x16_bf16 v[116:131], v[36:39], v[148:151], v[116:131]
  v_lshlrev_b32 v194, 16, v27
  v_and_b32 v195, 0xffff0000, v27
  v_mul_f32 v178, v178, v242
  v_mul_f32 v179, v179, v243
  v_mul_f32 v178, v178, v13
  v_mul_f32 v179, v179, v13
  v_mfma_f32_32x32x16_bf16 v[132:147], v[60:63], v[148:151], v[132:147]
  ds_read_b128 v[148:151], v7 offset:26624
  v_cvt_pk_bf16_f32 v171, v178, v179
  v_mov_b32 v177, 0
  v_mov_b32 v178, 0
  v_mov_b32 v179, 0
  buffer_store_dwordx4 v[100:103], v112, s[76:79], s74 offen sc0 sc1
  s_waitcnt lgkmcnt(3)
  v_mfma_f32_32x32x16_bf16 v[116:131], v[40:43], v[152:155], v[116:131]
  v_add_u32 v11, s42, v7
  v_add_u32 v10, s73, v7
  v_mul_f32 v196, v196, v228
  v_mul_f32 v197, v197, v229
  v_mul_f32 v198, v198, v230
  v_mul_f32 v199, v199, v231
  v_mfma_f32_32x32x16_bf16 v[132:147], v[64:67], v[152:155], v[132:147]
  ds_read_b128 v[152:155], v7 offset:27648
  v_mul_f32 v200, v200, v232
  v_mul_f32 v201, v201, v233
  v_mul_f32 v202, v202, v234
  v_mul_f32 v203, v203, v235
  v_max3_f32 v14, v196, v197, v198
  v_mul_f32 v204, v204, v236
  v_cvt_pk_bf16_f32 v68, v116, v117
  v_cvt_pk_bf16_f32 v69, v118, v119
  v_cvt_pk_bf16_f32 v70, v120, v121
  v_cvt_pk_bf16_f32 v71, v122, v123
  v_cvt_pk_bf16_f32 v72, v124, v125
  v_cvt_pk_bf16_f32 v73, v126, v127
  v_cvt_pk_bf16_f32 v74, v128, v129
  v_cvt_pk_bf16_f32 v75, v130, v131
  s_waitcnt lgkmcnt(3)
  v_mfma_f32_32x32x16_bf16 v[116:131], v[20:23], v[156:159], 0
  v_cvt_pk_bf16_f32 v92, v132, v133
  v_cvt_pk_bf16_f32 v93, v134, v135
  v_cvt_pk_bf16_f32 v94, v136, v137
  v_cvt_pk_bf16_f32 v95, v138, v139
  v_cvt_pk_bf16_f32 v96, v140, v141
  v_cvt_pk_bf16_f32 v97, v142, v143
  v_cvt_pk_bf16_f32 v98, v144, v145
  v_cvt_pk_bf16_f32 v99, v146, v147
  v_mfma_f32_32x32x16_bf16 v[132:147], v[44:47], v[156:159], 0
  ds_read_b128 v[156:159], v7 offset:28672
  v_mul_f32 v205, v205, v237
  v_mul_f32 v206, v206, v238
  v_mul_f32 v207, v207, v239
  v_max3_f32 v16, v199, v200, v201
  v_max3_f32 v14, v14, v202, v203
  s_waitcnt lgkmcnt(3)
  v_mfma_f32_32x32x16_bf16 v[116:131], v[24:27], v[160:163], v[116:131]
  v_mul_f32 v208, v208, v240
  v_mul_f32 v209, v209, v241
  v_mul_f32 v210, v210, v242
  v_mul_f32 v211, v211, v243
  v_max3_f32 v16, v16, v204, v205
  v_max3_f32 v14, v14, v206, v207
  v_mfma_f32_32x32x16_bf16 v[132:147], v[48:51], v[160:163], v[132:147]
  ds_read_b128 v[160:163], v7 offset:29696
  v_mul_f32 v212, v212, v244
  v_mul_f32 v213, v213, v245
  v_mul_f32 v214, v214, v246
  v_mul_f32 v215, v215, v247
  v_max3_f32 v16, v16, v208, v209
  s_waitcnt lgkmcnt(3)
  v_mfma_f32_32x32x16_bf16 v[116:131], v[28:31], v[148:151], v[116:131]
  v_max3_f32 v14, v14, v210, v211
  v_mul_f32 v216, v216, v248
  v_mul_f32 v217, v217, v249
  v_mul_f32 v218, v218, v250
  v_mul_f32 v219, v219, v251
  v_mul_f32 v220, v220, v252
  v_mfma_f32_32x32x16_bf16 v[132:147], v[52:55], v[148:151], v[132:147]
  ds_read_b128 v[148:151], v7 offset:30720
  v_max3_f32 v16, v16, v212, v213
  v_max3_f32 v14, v14, v214, v215
  v_cndmask_b32_e64 v220, v220, v219, s[38:39]
  v_max3_f32 v16, v16, v216, v217
  v_max3_f32 v14, v14, v218, v219
  s_waitcnt lgkmcnt(3)
  v_mfma_f32_32x32x16_bf16 v[116:131], v[32:35], v[152:155], v[116:131]
  v_max3_f32 v14, v14, v16, v220
  v_and_b32 v221, 0xffff0000, v64
  v_mov_b32 v16, v14
  v_lshlrev_b32 v222, 16, v65
  v_and_b32 v223, 0xffff0000, v65
  v_permlane32_swap_b32 v14, v16
  v_mfma_f32_32x32x16_bf16 v[132:147], v[56:59], v[152:155], v[132:147]
  ds_read_b128 v[152:155], v7 offset:31744
  v_max_f32 v14, v14, v16
  v_lshlrev_b32 v224, 16, v66
  v_mul_f32 v14, v14, v9
  v_and_b32 v225, 0xffff0000, v66
  v_fma_f32 v196, v196, v9, -v14
  s_waitcnt lgkmcnt(3)
  v_mfma_f32_32x32x16_bf16 v[116:131], v[36:39], v[156:159], v[116:131]
  v_fma_f32 v197, v197, v9, -v14
  v_fma_f32 v198, v198, v9, -v14
  v_fma_f32 v199, v199, v9, -v14
  v_fma_f32 v200, v200, v9, -v14
  v_exp_f32 v196, v196
  v_mfma_f32_32x32x16_bf16 v[132:147], v[60:63], v[156:159], v[132:147]
  ds_read_b128 v[156:159], v7 offset:32768
  v_exp_f32 v197, v197
  v_fma_f32 v201, v201, v9, -v14
  v_fma_f32 v202, v202, v9, -v14
  v_exp_f32 v198, v198
  s_waitcnt lgkmcnt(3)
  v_mfma_f32_32x32x16_bf16 v[116:131], v[40:43], v[160:163], v[116:131]
  v_exp_f32 v199, v199
  v_exp_f32 v200, v200
  v_fma_f32 v203, v203, v9, -v14
  v_fma_f32 v204, v204, v9, -v14
  v_mfma_f32_32x32x16_bf16 v[132:147], v[64:67], v[160:163], v[132:147]
  ds_read_b128 v[160:163], v7 offset:33792
  v_exp_f32 v201, v201
  v_exp_f32 v202, v202
  v_add_f32 v15, v196, v197
  v_mfma_f32_32x32x16_bf16 v[180:195], v[68:71], v[164:167], v[180:195]
  s_nop 1
  v_cvt_pk_bf16_f32 v76, v116, v117
  v_cvt_pk_bf16_f32 v77, v118, v119
  v_cvt_pk_bf16_f32 v78, v120, v121
  v_cvt_pk_bf16_f32 v79, v122, v123
  v_cvt_pk_bf16_f32 v80, v124, v125
  v_cvt_pk_bf16_f32 v81, v126, v127
  v_mfma_f32_32x32x16_bf16 v[180:195], v[72:75], v[168:171], v[180:195]
  v_cvt_pk_bf16_f32 v82, v128, v129
  v_cvt_pk_bf16_f32 v83, v130, v131
  v_cvt_pk_bf16_f32 v100, v132, v133
  v_cvt_pk_bf16_f32 v101, v134, v135
  v_cvt_pk_bf16_f32 v102, v136, v137
  v_cvt_pk_bf16_f32 v103, v138, v139
  v_mfma_f32_32x32x16_bf16 v[180:195], v[92:95], v[172:175], v[180:195]
  v_cvt_pk_bf16_f32 v104, v140, v141
  v_cvt_pk_bf16_f32 v105, v142, v143
  v_cvt_pk_bf16_f32 v106, v144, v145
  v_cvt_pk_bf16_f32 v107, v146, v147
  v_fma_f32 v205, v205, v9, -v14
  v_fma_f32 v206, v206, v9, -v14
  v_mfma_f32_32x32x16_bf16 v[180:195], v[96:99], v[176:179], v[180:195]
  v_exp_f32 v203, v203
  v_exp_f32 v204, v204
  v_add_f32 v17, v198, v199
  v_add_f32 v15, v15, v200
  s_waitcnt lgkmcnt(3)
  v_mfma_f32_32x32x16_bf16 v[116:131], v[20:23], v[148:151], 0
  ds_read_b128 v[20:23], v11
  v_fma_f32 v207, v207, v9, -v14
  v_fma_f32 v208, v208, v9, -v14
  v_exp_f32 v205, v205
  v_exp_f32 v206, v206
  v_mfma_f32_32x32x16_bf16 v[132:147], v[44:47], v[148:151], 0
  ds_read_b128 v[148:151], v7 offset:34816
  v_cvt_pk_bf16_f32 v180, v180, v181
  v_cvt_pk_bf16_f32 v181, v182, v183
  v_cvt_pk_bf16_f32 v182, v184, v185
  v_cvt_pk_bf16_f32 v183, v186, v187
  v_cvt_pk_bf16_f32 v188, v188, v189
  s_waitcnt lgkmcnt(4)
  v_mfma_f32_32x32x16_bf16 v[116:131], v[24:27], v[152:155], v[116:131]
  v_cvt_pk_bf16_f32 v189, v190, v191
  v_cvt_pk_bf16_f32 v190, v192, v193
  v_cvt_pk_bf16_f32 v191, v194, v195
  ds_write_b128 v18, v[180:183] offset:0
  ds_write_b128 v19, v[188:191] offset:0
  v_mfma_f32_32x32x16_bf16 v[132:147], v[48:51], v[152:155], v[132:147]
  ds_read_b128 v[152:155], v7 offset:35840
  v_lshlrev_b32 v180, 16, v28
  v_and_b32 v181, 0xffff0000, v28
  v_lshlrev_b32 v182, 16, v29
  v_and_b32 v183, 0xffff0000, v29
  v_lshlrev_b32 v184, 16, v30
  s_waitcnt lgkmcnt(6)
  v_mfma_f32_32x32x16_bf16 v[116:131], v[28:31], v[156:159], v[116:131]
  v_and_b32 v185, 0xffff0000, v30
  v_lshlrev_b32 v186, 16, v31
  v_and_b32 v187, 0xffff0000, v31
  v_lshlrev_b32 v188, 16, v32
  v_and_b32 v189, 0xffff0000, v32
  v_lshlrev_b32 v190, 16, v33
  v_mfma_f32_32x32x16_bf16 v[132:147], v[52:55], v[156:159], v[132:147]
  v_and_b32 v191, 0xffff0000, v33
  v_lshlrev_b32 v192, 16, v34
  v_and_b32 v193, 0xffff0000, v34
  v_lshlrev_b32 v194, 16, v35
  v_and_b32 v195, 0xffff0000, v35
  v_lshlrev_b32 v156, 16, v40
  s_waitcnt lgkmcnt(5)
  v_mfma_f32_32x32x16_bf16 v[116:131], v[32:35], v[160:163], v[116:131]
  v_and_b32 v157, 0xffff0000, v40
  v_lshlrev_b32 v158, 16, v41
  v_and_b32 v159, 0xffff0000, v41
  ds_read_b128 v[24:27], v11 offset:1024
  v_add_f32 v17, v17, v201
  v_add_f32 v15, v15, v202
  v_mfma_f32_32x32x16_bf16 v[132:147], v[56:59], v[160:163], v[132:147]
  v_lshlrev_b32 v160, 16, v42
  v_and_b32 v161, 0xffff0000, v42
  v_lshlrev_b32 v162, 16, v43
  v_and_b32 v163, 0xffff0000, v43
  v_fma_f32 v209, v209, v9, -v14
  v_fma_f32 v210, v210, v9, -v14
  s_waitcnt lgkmcnt(4)
  v_mfma_f32_32x32x16_bf16 v[116:131], v[36:39], v[148:151], v[116:131]
  v_exp_f32 v207, v207
  v_exp_f32 v208, v208
  v_add_f32 v17, v17, v203
  v_add_f32 v15, v15, v204
  v_mfma_f32_32x32x16_bf16 v[132:147], v[60:63], v[148:151], v[132:147]
  v_lshlrev_b32 v148, 16, v36
  v_and_b32 v149, 0xffff0000, v36
  v_lshlrev_b32 v150, 16, v37
  v_and_b32 v151, 0xffff0000, v37
  v_fma_f32 v211, v211, v9, -v14
  v_fma_f32 v212, v212, v9, -v14
  s_waitcnt lgkmcnt(1)
  v_mfma_f32_32x32x16_bf16 v[116:131], v[40:43], v[152:155], v[116:131]
  v_exp_f32 v209, v209
  v_exp_f32 v210, v210
  v_add_f32 v17, v17, v205
  v_add_f32 v15, v15, v206
  v_mfma_f32_32x32x16_bf16 v[132:147], v[64:67], v[152:155], v[132:147]
  v_lshlrev_b32 v152, 16, v38
  v_and_b32 v153, 0xffff0000, v38
  v_lshlrev_b32 v154, 16, v39
  v_and_b32 v155, 0xffff0000, v39
  v_fma_f32 v213, v213, v9, -v14
  v_fma_f32 v214, v214, v9, -v14
  v_mfma_f32_32x32x16_bf16 v[180:195], v[76:79], v[164:167], v[180:195]
  v_cvt_pk_bf16_f32 v84, v116, v117
  v_cvt_pk_bf16_f32 v85, v118, v119
  v_cvt_pk_bf16_f32 v86, v120, v121
  v_cvt_pk_bf16_f32 v87, v122, v123
  v_cvt_pk_bf16_f32 v88, v124, v125
  v_cvt_pk_bf16_f32 v89, v126, v127
  v_mfma_f32_32x32x16_bf16 v[180:195], v[80:83], v[168:171], v[180:195]
  v_cvt_pk_bf16_f32 v90, v128, v129
  v_cvt_pk_bf16_f32 v91, v130, v131
  v_cvt_pk_bf16_f32 v108, v132, v133
  v_cvt_pk_bf16_f32 v109, v134, v135
  v_cvt_pk_bf16_f32 v110, v136, v137
  v_cvt_pk_bf16_f32 v111, v138, v139
  v_mfma_f32_32x32x16_bf16 v[180:195], v[100:103], v[172:175], v[180:195]
  v_cvt_pk_bf16_f32 v112, v140, v141
  v_cvt_pk_bf16_f32 v113, v142, v143
  v_cvt_pk_bf16_f32 v114, v144, v145
  v_cvt_pk_bf16_f32 v115, v146, v147
  v_exp_f32 v211, v211
  v_mfma_f32_32x32x16_bf16 v[180:195], v[104:107], v[176:179], v[180:195]
  v_exp_f32 v212, v212
  v_add_f32 v17, v17, v207
  v_add_f32 v15, v15, v208
  v_fma_f32 v215, v215, v9, -v14
  v_fma_f32 v216, v216, v9, -v14
  v_mfma_f32_32x32x16_bf16 v[148:163], v[84:87], v[164:167], v[148:163]
  v_exp_f32 v213, v213
  v_exp_f32 v214, v214
  v_add_f32 v17, v17, v209
  v_add_f32 v15, v15, v210
  v_mfma_f32_32x32x16_bf16 v[148:163], v[88:91], v[168:171], v[148:163]
  s_nop 0
  v_cvt_pk_bf16_f32 v180, v180, v181
  v_cvt_pk_bf16_f32 v181, v182, v183
  v_cvt_pk_bf16_f32 v182, v184, v185
  v_cvt_pk_bf16_f32 v183, v186, v187
  v_cvt_pk_bf16_f32 v188, v188, v189
  v_cvt_pk_bf16_f32 v189, v190, v191
  v_mfma_f32_32x32x16_bf16 v[148:163], v[108:111], v[172:175], v[148:163]
  v_cvt_pk_bf16_f32 v190, v192, v193
  v_cvt_pk_bf16_f32 v191, v194, v195
  ds_write_b128 v18, v[180:183] offset:64
  ds_write_b128 v19, v[188:191] offset:64
  v_mfma_f32_32x32x16_bf16 v[148:163], v[112:115], v[176:179], v[148:163]
  v_fma_f32 v217, v217, v9, -v14
  v_fma_f32 v218, v218, v9, -v14
  v_fma_f32 v220, v220, v9, -v14
  v_exp_f32 v215, v215
  v_exp_f32 v216, v216
  v_add_f32 v17, v17, v211
  v_add_f32 v15, v15, v212
  v_fma_f32 v219, v219, v9, -v14
  v_exp_f32 v217, v217
  v_exp_f32 v218, v218
  v_exp_f32 v220, v220
  s_nop 0
  v_cvt_pk_bf16_f32 v148, v148, v149
  v_cvt_pk_bf16_f32 v149, v150, v151
  v_cvt_pk_bf16_f32 v150, v152, v153
  v_cvt_pk_bf16_f32 v151, v154, v155
  v_cvt_pk_bf16_f32 v156, v156, v157
  v_cvt_pk_bf16_f32 v157, v158, v159
  v_cvt_pk_bf16_f32 v158, v160, v161
  v_cvt_pk_bf16_f32 v159, v162, v163
  ds_write_b128 v18, v[148:151] offset:128
  ds_write_b128 v19, v[156:159] offset:128
  ds_read_b128 v[28:31], v10 offset:0
  ds_read_b128 v[32:35], v10 offset:1024
  ds_read_b128 v[36:39], v10 offset:2048
  ds_read_b128 v[40:43], v10 offset:3072
  v_add_f32 v17, v17, v213
  v_add_f32 v15, v15, v214
  v_exp_f32 v219, v219
  v_add_f32 v17, v17, v215
  v_add_f32 v15, v15, v216
  v_cndmask_b32_e64 v220, v220, 0, s[38:39]
  v_add_f32 v17, v17, v217
  v_add_f32 v15, v15, v218
  v_add_f32 v17, v17, v219
  v_add_f32 v15, v15, v220
  v_mul_f32 v196, v196, v228
  v_add_f32 v15, v15, v17
  v_mul_f32 v197, v197, v229
  v_mov_b32 v17, v15
  v_mul_f32 v198, v198, v230
  v_mul_f32 v199, v199, v231
  v_permlane32_swap_b32 v15, v17
  v_add_f32 v15, v15, v17
  v_mul_f32 v200, v200, v232
  v_rcp_f32 v15, v15
  v_mul_f32 v201, v201, v233
  v_mul_f32 v202, v202, v234
  v_mul_f32 v203, v203, v235
  s_waitcnt lgkmcnt(3)
  buffer_store_dwordx4 v[28:31], v20, s[12:15], s24 offen sc0 sc1
  v_mul_f32 v196, v196, v15
  s_nop 0
  ds_read_b128 v[28:31], v10 offset:4096
  v_mul_f32 v197, v197, v15
  v_mul_f32 v198, v198, v15
  v_mul_f32 v199, v199, v15
  v_mul_f32 v200, v200, v15
  v_mul_f32 v201, v201, v15
  v_mul_f32 v202, v202, v15
  v_mul_f32 v203, v203, v15
  v_cvt_pk_bf16_f32 v196, v196, v197
  v_cvt_pk_bf16_f32 v197, v198, v199
  v_cvt_pk_bf16_f32 v198, v200, v201
  v_cvt_pk_bf16_f32 v199, v202, v203
  v_lshlrev_b32 v116, 16, v44
  v_and_b32 v117, 0xffff0000, v44
  v_lshlrev_b32 v118, 16, v45
  v_and_b32 v119, 0xffff0000, v45
  v_lshlrev_b32 v120, 16, v46
  v_and_b32 v121, 0xffff0000, v46
  v_lshlrev_b32 v122, 16, v47
  v_and_b32 v123, 0xffff0000, v47
  v_lshlrev_b32 v124, 16, v48
  v_and_b32 v125, 0xffff0000, v48
  s_waitcnt lgkmcnt(3)
  buffer_store_dwordx4 v[32:35], v21, s[12:15], s24 offen sc0 sc1
  v_lshlrev_b32 v126, 16, v49
  s_nop 0
  ds_read_b128 v[32:35], v10 offset:5120
  v_and_b32 v127, 0xffff0000, v49
  v_lshlrev_b32 v128, 16, v50
  v_and_b32 v129, 0xffff0000, v50
  v_lshlrev_b32 v130, 16, v51
  v_and_b32 v131, 0xffff0000, v51
  v_mul_f32 v204, v204, v236
  v_mul_f32 v205, v205, v237
  v_mfma_f32_32x32x16_bf16 v[116:131], v[68:71], v[196:199], v[116:131]
  v_mul_f32 v206, v206, v238
  v_mul_f32 v207, v207, v239
  v_mul_f32 v208, v208, v240
  v_mul_f32 v209, v209, v241
  v_mul_f32 v210, v210, v242
  v_mul_f32 v211, v211, v243
  v_mul_f32 v204, v204, v15
  v_mul_f32 v205, v205, v15
  v_mul_f32 v206, v206, v15
  v_mul_f32 v207, v207, v15
  v_mul_f32 v208, v208, v15
  v_mul_f32 v209, v209, v15
  s_waitcnt lgkmcnt(3)
  buffer_store_dwordx4 v[36:39], v22, s[12:15], s24 offen sc0 sc1
  v_mul_f32 v210, v210, v15
  v_mul_f32 v211, v211, v15
  v_cvt_pk_bf16_f32 v200, v204, v205
  v_cvt_pk_bf16_f32 v201, v206, v207
  v_cvt_pk_bf16_f32 v202, v208, v209
  v_cvt_pk_bf16_f32 v203, v210, v211
  v_mul_f32 v212, v212, v244
  v_mul_f32 v213, v213, v245
  v_mfma_f32_32x32x16_bf16 v[116:131], v[72:75], v[200:203], v[116:131]
  v_mul_f32 v214, v214, v246
  v_mul_f32 v215, v215, v247
  v_mul_f32 v216, v216, v248
  v_mul_f32 v217, v217, v249
  v_mul_f32 v218, v218, v250
  v_mul_f32 v219, v219, v251
  v_mul_f32 v212, v212, v15
  s_cbranch_vccz S_NOBAR
  s_waitcnt vmcnt(7)
  s_barrier
S_NOBAR:
  v_mul_f32 v213, v213, v15
  v_mul_f32 v214, v214, v15
  v_mul_f32 v215, v215, v15
  v_mul_f32 v216, v216, v15
  v_mul_f32 v217, v217, v15
  v_mul_f32 v218, v218, v15
  s_waitcnt lgkmcnt(2)
  buffer_store_dwordx4 v[40:43], v23, s[12:15], s24 offen sc0 sc1
  v_mul_f32 v219, v219, v15
  v_cvt_pk_bf16_f32 v204, v212, v213
  v_cvt_pk_bf16_f32 v205, v214, v215
  v_cvt_pk_bf16_f32 v206, v216, v217
  v_cvt_pk_bf16_f32 v207, v218, v219
  v_mul_f32 v220, v220, v252
  v_mov_b32 v209, 0
  v_mfma_f32_32x32x16_bf16 v[116:131], v[92:95], v[204:207], v[116:131]
  v_mul_f32 v220, v220, v15
  v_mov_b32 v210, 0
  v_cvt_pk_bf16_f32 v208, v220, 0
  v_mov_b32 v211, 0
  v_lshlrev_b32 v132, 16, v52
  v_and_b32 v133, 0xffff0000, v52
  v_mfma_f32_32x32x16_bf16 v[116:131], v[96:99], v[208:211], v[116:131]
  v_lshlrev_b32 v134, 16, v53
  v_and_b32 v135, 0xffff0000, v53
  v_lshlrev_b32 v136, 16, v54
  v_and_b32 v137, 0xffff0000, v54
  v_lshlrev_b32 v138, 16, v55
  v_and_b32 v139, 0xffff0000, v55
  s_waitcnt lgkmcnt(1)
  buffer_store_dwordx4 v[28:31], v24, s[12:15], s24 offen sc0 sc1
  v_lshlrev_b32 v140, 16, v56
  v_and_b32 v141, 0xffff0000, v56
  v_lshlrev_b32 v142, 16, v57
  v_and_b32 v143, 0xffff0000, v57
  v_lshlrev_b32 v144, 16, v58
  v_and_b32 v145, 0xffff0000, v58
  v_lshlrev_b32 v146, 16, v59
  v_and_b32 v147, 0xffff0000, v59
  v_lshlrev_b32 v212, 16, v60
  v_and_b32 v213, 0xffff0000, v60
  v_mfma_f32_32x32x16_bf16 v[132:147], v[76:79], v[196:199], v[132:147]
  v_lshlrev_b32 v214, 16, v61
  v_and_b32 v215, 0xffff0000, v61
  v_lshlrev_b32 v216, 16, v62
  v_and_b32 v217, 0xffff0000, v62
  v_lshlrev_b32 v218, 16, v63
  v_and_b32 v219, 0xffff0000, v63
  v_mfma_f32_32x32x16_bf16 v[132:147], v[80:83], v[200:203], v[132:147]
  v_lshlrev_b32 v220, 16, v64
  v_lshlrev_b32 v226, 16, v67
  v_and_b32 v227, 0xffff0000, v67
  s_waitcnt lgkmcnt(0)
  buffer_store_dwordx4 v[32:35], v25, s[12:15], s24 offen sc0 sc1
  v_add_u32 v13, 0x1800, v18
  v_mfma_f32_32x32x16_bf16 v[132:147], v[100:103], v[204:207], v[132:147]
  v_cndmask_b32_e64 v13, v13, v2, s[40:41]
  v_cvt_pk_bf16_f32 v116, v116, v117
  v_cvt_pk_bf16_f32 v117, v118, v119
  v_cvt_pk_bf16_f32 v118, v120, v121
  v_cvt_pk_bf16_f32 v119, v122, v123
  v_cvt_pk_bf16_f32 v124, v124, v125
  v_mfma_f32_32x32x16_bf16 v[132:147], v[104:107], v[208:211], v[132:147]
  v_cvt_pk_bf16_f32 v125, v126, v127
  v_xor_b32 v12, 32, v13
  v_cvt_pk_bf16_f32 v126, v128, v129
  v_cvt_pk_bf16_f32 v127, v130, v131
  ds_write_b128 v13, v[116:119] offset:0
  v_mfma_f32_32x32x16_bf16 v[212:227], v[84:87], v[196:199], v[212:227]
  ds_write_b128 v12, v[124:127] offset:0
  s_add_u32 s24, s24, 0x540
  v_add_u32 v2, 0x300, v2
  s_add_u32 s25, s25, 1
  s_cmp_lt_u32 s25, 5
  v_mfma_f32_32x32x16_bf16 v[212:227], v[88:91], v[200:203], v[212:227]
  v_cvt_pk_bf16_f32 v132, v132, v133
  v_cvt_pk_bf16_f32 v133, v134, v135
  v_cvt_pk_bf16_f32 v134, v136, v137
  v_cvt_pk_bf16_f32 v135, v138, v139
  v_cvt_pk_bf16_f32 v140, v140, v141
  v_cvt_pk_bf16_f32 v141, v142, v143
  v_mfma_f32_32x32x16_bf16 v[212:227], v[108:111], v[204:207], v[212:227]
  v_cvt_pk_bf16_f32 v142, v144, v145
  v_cvt_pk_bf16_f32 v143, v146, v147
  ds_write_b128 v13, v[132:135] offset:64
  ds_write_b128 v12, v[140:143] offset:64
  v_mfma_f32_32x32x16_bf16 v[212:227], v[112:115], v[208:211], v[212:227]
  s_nop 11
  v_cvt_pk_bf16_f32 v212, v212, v213
  v_cvt_pk_bf16_f32 v213, v214, v215
  v_cvt_pk_bf16_f32 v214, v216, v217
  v_cvt_pk_bf16_f32 v215, v218, v219
  v_cvt_pk_bf16_f32 v220, v220, v221
  v_cvt_pk_bf16_f32 v221, v222, v223
  v_cvt_pk_bf16_f32 v222, v224, v225
  v_cvt_pk_bf16_f32 v223, v226, v227
  ds_write_b128 v13, v[212:215] offset:128
  ds_write_b128 v12, v[220:223] offset:128
  s_cbranch_scc1 S_LOOP
S_FIN:
  v_subrev_u32 v120, 0x9000, v7
  v_add_u32 v119, s42, v7
  v_lshrrev_b32 v120, 2, v120
  v_add_u32 v156, s73, v7
  v_add_u32 v120, s43, v120
  v_subrev_u32 v157, 0x300, v5
  ds_read_b128 v[108:111], v119 offset:1024
  ds_read_b32 v112, v120
  ds_read_b128 v[188:191], v156 offset:6144
  ds_read_b128 v[192:195], v156 offset:7168
  ds_read_b128 v[196:199], v156 offset:8192
  ds_read_b128 v[200:203], v157
  s_sub_u32 s74, s24, 0x540
  ds_read_b128 v[104:107], v119
  s_waitcnt lgkmcnt(4)
  buffer_store_dwordx4 v[188:191], v110, s[12:15], s74 offen sc0 sc1
  s_waitcnt lgkmcnt(3)
  buffer_store_dwordx4 v[192:195], v111, s[12:15], s74 offen sc0 sc1
  s_waitcnt lgkmcnt(2)
  buffer_store_dwordx4 v[196:199], v112, s[12:15], s74 offen sc0 sc1
  s_waitcnt lgkmcnt(1)
  buffer_store_dwordx4 v[200:203], v0, s[12:15], s74 offen sc0 sc1
MAIN_END:
  s_endpgm
.section .rodata,"a"
.p2align 6
.amdhsa_kernel standalone__video_video_swin__vision_kernel
  .amdhsa_next_free_vgpr 256
  .amdhsa_next_free_sgpr 102
  .amdhsa_accum_offset 256
  .amdhsa_group_segment_fixed_size 0
  .amdhsa_kernarg_size 64
  .amdhsa_user_sgpr_count 2
  .amdhsa_user_sgpr_kernarg_segment_ptr 1
  .amdhsa_system_sgpr_workgroup_id_x 1
.end_amdhsa_kernel
```
